```python
import torch

def _softmax(x, axis=-1):
    return torch.softmax(x, dim=axis)
def _gelu(x):
    return torch.nn.functional.gelu(x, approximate="tanh")
def _silu(x):
    return torch.nn.functional.silu(x)
def _sigmoid(x):
    return torch.sigmoid(x)
def _layernorm(x, axis=-1, eps=1e-5):
    m = x.mean(dim=axis, keepdim=True)
    v = x.var(dim=axis, keepdim=True, unbiased=False)
    return (x - m) / torch.sqrt(v + eps)
def _scatter_add(tgt, idx, src, axis=0):
    return tgt.clone().index_add_(axis, idx, src)
def _segment_sum(src, seg, n):
    out = torch.zeros((n,) + src.shape[1:], dtype=src.dtype)
    return out.index_add_(0, seg, src)
def _pad(x, pw):
    flat = tuple(v for pair in reversed(pw) for v in pair)
    return torch.nn.functional.pad(x, flat)

kernel_name = 'sequential_preLN__mha_block_cached__swiglu_ffn__decode'

def setup_inputs():

    _w = (lambda a: (lambda t: t.to(torch.bfloat16) if t.is_floating_point() else t)(torch.as_tensor(a)))
    def _A_setup():
        B, Sq, D = 1, 1, 640
        H, Sk, Dh = 32, 32768, 192
        return {
            "x": _w((lambda *s: torch.randn(*s, dtype=torch.bfloat16) * 0.05)(B, Sq, D)),
            "k_cache": _w((lambda *s: torch.randn(*s, dtype=torch.bfloat16) * 3.2)(B, H, Sk, Dh)),
            "v_cache": _w((lambda *s: torch.randn(*s, dtype=torch.bfloat16) * 0.4)(B, H, Sk, Dh)),
            "wq": _w((lambda *s: torch.randn(*s, dtype=torch.bfloat16) * 3.2)(D, H * Dh) * (D ** -0.5)),
            "wo": _w((lambda *s: torch.randn(*s, dtype=torch.bfloat16) * 0.4)(H * Dh, D) * ((H * Dh) ** -0.5)),
        }
    _A_in = _A_setup()

    def _B_setup():
        B, S, D, F = 1, 1, 640, 1536
        return {
            "x": _w((lambda *s: torch.randn(*s, dtype=torch.bfloat16) * 0.05)(B, S, D)),
            "w_gate": _w((lambda *s: torch.randn(*s, dtype=torch.bfloat16) * 0.05)(D, F)),
            "w_up": _w((lambda *s: torch.randn(*s, dtype=torch.bfloat16) * 0.05)(D, F)),
            "w_down": _w((lambda *s: torch.randn(*s, dtype=torch.bfloat16) * 0.05)(F, D)),
        }
    _B_in = _B_setup()

    return {
        "A_x": _A_in["x"],
        "A_k_cache": _A_in["k_cache"],
        "A_v_cache": _A_in["v_cache"],
        "A_wq": _A_in["wq"],
        "A_wo": _A_in["wo"],
        "B_x": _B_in["x"],
        "B_w_gate": _B_in["w_gate"],
        "B_w_up": _B_in["w_up"],
        "B_w_down": _B_in["w_down"],
    }

def reference(A_x, A_k_cache, A_v_cache, A_wq, A_wo, B_x, B_w_gate, B_w_up, B_w_down):
    def _A_ref(x, k_cache, v_cache, wq, wo):
        B, Sq, D = x.shape
        H, Dh = 32, 192
        q = (lambda x, *d: x.permute(*d))((x @ wq).reshape(B, Sq, H, Dh), 0, 2, 1, 3)
        scores = torch.einsum("bhqd,bhkd->bhqk", q, k_cache) * (Dh ** -0.5)
        p = _softmax(scores, axis=-1)
        o = torch.einsum("bhqk,bhkd->bhqd", p, v_cache)
        return (lambda x, *d: x.permute(*d))(o, 0, 2, 1, 3).reshape(B, Sq, H * Dh) @ wo

    def _B_ref(x, w_gate, w_up, w_down):
        g = _silu(x @ w_gate)
        u = x @ w_up
        return (g * u) @ w_down

    x = A_x
    h = x + _A_ref(_layernorm(x, axis=-1), A_k_cache, A_v_cache, A_wq, A_wo)
    h2 = h + _B_ref(_layernorm(h, axis=-1), B_w_gate, B_w_up, B_w_down)
    return h2
```

```asm
; @launch grid=(256,1,1) block=(512,1,1) lds=135424
.amdgcn_target "amdgcn-amd-amdhsa--gfx950"
.text
.globl sequential_preLN__mha_block_cached__swiglu_ffn__decode_kernel
.p2align 8
.type sequential_preLN__mha_block_cached__swiglu_ffn__decode_kernel,@function
sequential_preLN__mha_block_cached__swiglu_ffn__decode_kernel:
  s_load_dwordx2 s[8:9], s[0:1], 8
  s_load_dwordx2 s[12:13], s[0:1], 8
  s_load_dwordx2 s[24:25], s[0:1], 0
  s_load_dwordx2 s[16:17], s[0:1], 24
  s_load_dwordx2 s[64:65], s[0:1], 8
  s_load_dwordx2 s[66:67], s[0:1], 16
  s_load_dwordx2 s[20:21], s[0:1], 88
  s_load_dwordx2 s[44:45], s[0:1], 72
  s_load_dwordx2 s[48:49], s[0:1], 80
  s_cmp_ge_u32 s2, 256
  s_cbranch_scc1 L_exit
  v_lshrrev_b32 v3, 6, v0
  v_and_b32 v0, 63, v0
  v_readfirstlane_b32 s3, v3
  s_mov_b32 s10, 402653184
  s_mov_b32 s11, 0x20000
  s_mov_b32 s14, 402653184
  s_mov_b32 s15, 0x20000
  s_mov_b32 s26, 1280
  s_mov_b32 s27, 0x20000
  s_mov_b32 s18, 7864320
  s_mov_b32 s19, 0x20000
  s_and_b32 s52, s2, 7
  s_lshr_b32 s53, s2, 3
  s_cmp_lt_u32 s3, 4
  s_cbranch_scc1 L_helper
  v_lshrrev_b32 v3, 3, v0
  v_and_b32 v4, 7, v0
  v_lshlrev_b32 v4, 4, v4
  v_mul_u32_u24 v1, 384, v3
  v_add_u32 v1, v1, v4
  s_lshl_b32 s58, s52, 5
  s_add_u32 s58, s58, s53
  s_mul_i32 s50, s58, 5462
  s_lshr_b32 s50, s50, 16
  s_mul_i32 s60, s50, 12
  s_sub_u32 s60, s58, s60
  s_cmp_eq_u32 s50, 21
  s_cselect_b32 s28, 16, 48
  s_movk_i32 s29, 2048
  s_cselect_b32 s29, 688, s29
  s_mul_i32 s30, s50, 13
  s_cselect_b32 s30, 273, s30
  s_lshl_b32 s58, s60, 2
  s_add_u32 s30, s30, s58
  s_mul_i32 s31, s50, 12582912
  s_sub_u32 s55, s3, 4
  s_lshr_b32 s58, s55, 2
  s_mul_i32 s58, s58, s28
  s_and_b32 s59, s55, 3
  s_add_u32 s58, s58, s59
  s_add_u32 s58, s58, s30
  s_sub_u32 s59, s58, s29
  s_cselect_b32 s58, s58, s59
  s_mul_i32 s58, s58, 6144
  s_add_u32 s54, s31, s58
  s_add_u32 s68, s54, 3072
  s_waitcnt lgkmcnt(0)
  buffer_load_dwordx4 v[56:59], v1, s[8:11], s54 offen offset:0 nt
  buffer_load_dwordx4 v[60:63], v1, s[8:11], s54 offen offset:128 nt
  buffer_load_dwordx4 v[64:67], v1, s[8:11], s54 offen offset:256 nt
  buffer_load_dwordx4 v[68:71], v1, s[12:15], s68 offen offset:0 nt
  buffer_load_dwordx4 v[72:75], v1, s[12:15], s68 offen offset:128 nt
  buffer_load_dwordx4 v[76:79], v1, s[12:15], s68 offen offset:256 nt
  s_barrier
  s_mov_b32 s22, 1010432
  s_mov_b32 s23, 0x20000
  s_mov_b32 s46, 1280
  s_mov_b32 s47, 0x20000
  s_mov_b32 s61, 0x3d93cd3a
  s_mov_b32 s62, 0x3fb8aa3b
  s_mov_b32 s63, 0xffff0000
  s_mov_b32 s7, s3
  s_mov_b32 s71, 0
  s_mov_b32 s74, 0x05040100
  s_mov_b32 s75, 0x07060302
  s_mov_b32 s101, 0x100000
  s_load_dwordx2 s[72:73], s[20:21], 172032
  s_lshl_b32 s58, s52, 5
  s_add_u32 s58, s58, s53
  s_sub_u32 s58, s58, 32
  s_cmp_lt_u32 s58, 160
  s_cselect_b32 s5, 0, 3
  s_cselect_b32 s58, s58, 0
  s_cmp_eq_u32 s52, 0
  s_cselect_b32 s5, 1, s5
  s_mul_i32 s100, s58, 205
  s_lshr_b32 s100, s100, 11
  s_mul_i32 s4, s100, 10
  s_sub_u32 s4, s58, s4
  s_and_b32 s58, s100, 1
  s_lshl_b32 s58, s58, 3
  s_lshr_b32 s100, s100, 1
  s_add_u32 s100, s100, s58
  s_cmp_ge_u32 s100, 8
  s_cselect_b32 s5, 3, s5
  s_cmp_lt_u32 s60, 8
  s_cselect_b32 s36, 43, 42
  s_cmp_eq_u32 s52, 0
  s_cselect_b32 s37, 11, 18
  s_add_u32 s37, s37, s36
  s_lshl_b32 s37, s37, 2
  s_lshl_b32 s36, s36, 2
  s_lshl_b32 s38, s37, 1
  s_mul_i32 s58, s52, 14
  s_mul_i32 s51, s53, 9
  s_add_u32 s58, s58, s51
  s_add_u32 s58, s58, 8
  s_and_b32 s58, s58, 31
  s_add_u32 s58, s58, 1
  s_mul_i32 s51, s58, 43
  s_lshr_b32 s51, s51, 7
  s_mul_i32 s60, s51, 3
  s_sub_u32 s60, s58, s60
  s_cmp_eq_u32 s51, 0
  s_cselect_b32 s32, 2, 3
  s_cselect_b32 s58, 1, 0
  s_sub_u32 s60, s60, s58
  s_add_u32 s58, s52, 7
  s_and_b32 s58, s58, 7
  s_mul_i32 s58, s32, s58
  s_add_u32 s60, s60, s58
  s_lshl_b32 s32, s32, 3
  s_cmp_eq_u32 s51, 0
  s_movk_i32 s33, 2048
  s_cselect_b32 s33, 1360, s33
  s_cselect_b32 s35, 4227072, 0
  s_mul_i32 s34, s51, 25
  s_lshr_b32 s57, s32, 3
  s_mul_i32 s56, s57, 548
  s_lshl_b32 s57, s57, 2
  s_add_u32 s56, s56, s34
  s_lshl_b32 s56, s56, 1
  s_lshl_b32 s32, s32, 2
  s_lshl_b32 s58, s60, 2
  s_add_u32 s34, s34, s58
  s_add_u32 s58, s51, 21
  s_mul_i32 s58, s58, 12582912
  s_add_u32 s35, s35, s58
  s_mov_b32 s70, 0
  v_lshlrev_b32 v13, 3, v3
  v_add_u32 v13, 119808, v13
  v_lshlrev_b32 v2, 2, v4
  v_lshrrev_b32 v3, 4, v0
  v_lshl_add_u32 v2, v3, 4, v2
  v_bfe_u32 v3, v0, 3, 1
  v_lshl_add_u32 v2, v3, 2, v2
  s_lshl_b32 s58, s55, 10
  s_add_u32 s58, s58, 4096
  v_add_u32 v2, s58, v2
  v_mov_b32 v28, 0
  v_mov_b32 v29, 0
  v_mov_b32 v30, 0
  v_mov_b32 v31, 0
  v_mov_b32 v32, 0
  v_mov_b32 v33, 0
  v_mov_b32 v34, 0
  v_mov_b32 v35, 0
  v_mov_b32 v36, 0
  v_mov_b32 v37, 0
  v_mov_b32 v38, 0
  v_mov_b32 v39, 0
  v_mov_b32 v40, 0
  v_mov_b32 v41, 0
  v_mov_b32 v42, 0
  v_mov_b32 v43, 0
  v_mov_b32 v44, 0
  v_mov_b32 v45, 0
  v_mov_b32 v46, 0
  v_mov_b32 v47, 0
  v_mov_b32 v48, 0
  v_mov_b32 v49, 0
  v_mov_b32 v50, 0
  v_mov_b32 v51, 0
  v_mov_b32 v52, 0
  v_mov_b32 v53, 0xfe967699
  v_mov_b32 v14, 0
  v_mov_b32 v15, 1
  s_add_u32 s60, s55, 4
  s_lshr_b32 s58, s60, 2
  s_mul_i32 s58, s58, s28
  s_and_b32 s59, s60, 3
  s_add_u32 s58, s58, s59
  s_add_u32 s58, s58, s30
  s_sub_u32 s59, s58, s29
  s_cselect_b32 s58, s58, s59
  s_mul_i32 s58, s58, 6144
  s_add_u32 s54, s31, s58
  s_add_u32 s68, s54, 3072
  s_waitcnt vmcnt(3)
  buffer_load_dwordx4 v[80:83], v1, s[8:11], s54 offen offset:0 nt
  buffer_load_dwordx4 v[84:87], v1, s[8:11], s54 offen offset:128 nt
  buffer_load_dwordx4 v[88:91], v1, s[8:11], s54 offen offset:256 nt
  s_waitcnt vmcnt(3)
  buffer_load_dwordx4 v[92:95], v1, s[12:15], s68 offen offset:0 nt
  buffer_load_dwordx4 v[96:99], v1, s[12:15], s68 offen offset:128 nt
  buffer_load_dwordx4 v[100:103], v1, s[12:15], s68 offen offset:256 nt
  s_add_u32 s60, s55, 8
  s_lshr_b32 s58, s60, 2
  s_mul_i32 s58, s58, s28
  s_and_b32 s59, s60, 3
  s_add_u32 s58, s58, s59
  s_add_u32 s58, s58, s30
  s_sub_u32 s59, s58, s29
  s_cselect_b32 s58, s58, s59
  s_mul_i32 s58, s58, 6144
  s_add_u32 s54, s31, s58
  s_add_u32 s68, s54, 3072
  s_waitcnt vmcnt(3)
  buffer_load_dwordx4 v[104:107], v1, s[8:11], s54 offen offset:0 nt
  buffer_load_dwordx4 v[108:111], v1, s[8:11], s54 offen offset:128 nt
  buffer_load_dwordx4 v[112:115], v1, s[8:11], s54 offen offset:256 nt
  s_waitcnt vmcnt(3)
  buffer_load_dwordx4 v[116:119], v1, s[12:15], s68 offen offset:0 nt
  buffer_load_dwordx4 v[120:123], v1, s[12:15], s68 offen offset:128 nt
  buffer_load_dwordx4 v[124:127], v1, s[12:15], s68 offen offset:256 nt
  s_add_u32 s60, s55, 12
  s_lshr_b32 s58, s60, 2
  s_mul_i32 s58, s58, s28
  s_and_b32 s59, s60, 3
  s_add_u32 s58, s58, s59
  s_add_u32 s58, s58, s30
  s_sub_u32 s59, s58, s29
  s_cselect_b32 s58, s58, s59
  s_mul_i32 s58, s58, 6144
  s_add_u32 s54, s31, s58
  s_add_u32 s68, s54, 3072
  s_waitcnt vmcnt(3)
  buffer_load_dwordx4 v[128:131], v1, s[8:11], s54 offen offset:0 nt
  buffer_load_dwordx4 v[132:135], v1, s[8:11], s54 offen offset:128 nt
  buffer_load_dwordx4 v[136:139], v1, s[8:11], s54 offen offset:256 nt
  s_waitcnt vmcnt(3)
  buffer_load_dwordx4 v[140:143], v1, s[12:15], s68 offen offset:0 nt
  buffer_load_dwordx4 v[144:147], v1, s[12:15], s68 offen offset:128 nt
  buffer_load_dwordx4 v[148:151], v1, s[12:15], s68 offen offset:256 nt
  s_add_u32 s60, s55, 16
  s_lshr_b32 s58, s60, 2
  s_mul_i32 s58, s58, s28
  s_and_b32 s59, s60, 3
  s_add_u32 s58, s58, s59
  s_add_u32 s58, s58, s30
  s_sub_u32 s59, s58, s29
  s_cselect_b32 s58, s58, s59
  s_mul_i32 s58, s58, 6144
  s_add_u32 s54, s31, s58
  s_add_u32 s68, s54, 3072
  s_waitcnt vmcnt(3)
  buffer_load_dwordx4 v[152:155], v1, s[8:11], s54 offen offset:0 nt
  buffer_load_dwordx4 v[156:159], v1, s[8:11], s54 offen offset:128 nt
  buffer_load_dwordx4 v[160:163], v1, s[8:11], s54 offen offset:256 nt
  s_waitcnt vmcnt(3)
  buffer_load_dwordx4 v[164:167], v1, s[12:15], s68 offen offset:0 nt
  buffer_load_dwordx4 v[168:171], v1, s[12:15], s68 offen offset:128 nt
  buffer_load_dwordx4 v[172:175], v1, s[12:15], s68 offen offset:256 nt
  s_add_u32 s60, s55, 20
  s_lshr_b32 s58, s60, 2
  s_mul_i32 s58, s58, s28
  s_and_b32 s59, s60, 3
  s_add_u32 s58, s58, s59
  s_add_u32 s58, s58, s30
  s_sub_u32 s59, s58, s29
  s_cselect_b32 s58, s58, s59
  s_mul_i32 s58, s58, 6144
  s_add_u32 s54, s31, s58
  s_add_u32 s68, s54, 3072
  s_waitcnt vmcnt(3)
  buffer_load_dwordx4 v[176:179], v1, s[8:11], s54 offen offset:0 nt
  buffer_load_dwordx4 v[180:183], v1, s[8:11], s54 offen offset:128 nt
  buffer_load_dwordx4 v[184:187], v1, s[8:11], s54 offen offset:256 nt
  s_waitcnt vmcnt(3)
  buffer_load_dwordx4 v[188:191], v1, s[12:15], s68 offen offset:0 nt
  buffer_load_dwordx4 v[192:195], v1, s[12:15], s68 offen offset:128 nt
  buffer_load_dwordx4 v[196:199], v1, s[12:15], s68 offen offset:256 nt
  s_add_u32 s60, s55, 24
  s_lshr_b32 s58, s60, 2
  s_mul_i32 s58, s58, s28
  s_and_b32 s59, s60, 3
  s_add_u32 s58, s58, s59
  s_add_u32 s58, s58, s30
  s_sub_u32 s59, s58, s29
  s_cselect_b32 s58, s58, s59
  s_mul_i32 s58, s58, 6144
  s_add_u32 s54, s31, s58
  s_add_u32 s68, s54, 3072
  s_waitcnt vmcnt(3)
  buffer_load_dwordx4 v[200:203], v1, s[8:11], s54 offen offset:0 nt
  buffer_load_dwordx4 v[204:207], v1, s[8:11], s54 offen offset:128 nt
  buffer_load_dwordx4 v[208:211], v1, s[8:11], s54 offen offset:256 nt
  s_waitcnt vmcnt(3)
  buffer_load_dwordx4 v[212:215], v1, s[12:15], s68 offen offset:0 nt
  buffer_load_dwordx4 v[216:219], v1, s[12:15], s68 offen offset:128 nt
  buffer_load_dwordx4 v[220:223], v1, s[12:15], s68 offen offset:256 nt
  s_add_u32 s60, s55, 28
  s_lshr_b32 s58, s60, 2
  s_mul_i32 s58, s58, s28
  s_and_b32 s59, s60, 3
  s_add_u32 s58, s58, s59
  s_add_u32 s58, s58, s30
  s_sub_u32 s59, s58, s29
  s_cselect_b32 s58, s58, s59
  s_mul_i32 s58, s58, 6144
  s_add_u32 s54, s31, s58
  s_add_u32 s68, s54, 3072
  s_waitcnt vmcnt(3)
  buffer_load_dwordx4 v[224:227], v1, s[8:11], s54 offen offset:0 nt
  buffer_load_dwordx4 v[228:231], v1, s[8:11], s54 offen offset:128 nt
  buffer_load_dwordx4 v[232:235], v1, s[8:11], s54 offen offset:256 nt
  s_waitcnt vmcnt(3)
  buffer_load_dwordx4 v[236:239], v1, s[12:15], s68 offen offset:0 nt
  buffer_load_dwordx4 v[240:243], v1, s[12:15], s68 offen offset:128 nt
  buffer_load_dwordx4 v[244:247], v1, s[12:15], s68 offen offset:256 nt
  s_barrier
  ds_read_b128 v[16:19], v4 offset:8192
  ds_read_b128 v[20:23], v4 offset:8320
  ds_read_b128 v[24:27], v4 offset:8448
  s_waitcnt lgkmcnt(0)
  s_add_u32 s72, s72, 1
  s_mul_i32 s73, s73, 0x9e3779b1
  s_add_u32 s73, s73, 0x7f4a7c15
  s_mov_b64 exec, 1
  ds_add_rtn_u32 v55, v14, v15 offset:10304
  s_mov_b64 exec, -1
  s_mov_b32 s69, s55
  s_add_u32 s60, s55, 32
  s_lshr_b32 s58, s60, 2
  s_mul_i32 s58, s58, s28
  s_and_b32 s59, s60, 3
  s_add_u32 s58, s58, s59
  s_add_u32 s58, s58, s30
  s_sub_u32 s59, s58, s29
  s_cselect_b32 s58, s58, s59
  s_mul_i32 s58, s58, 6144
  s_add_u32 s54, s31, s58
  s_add_u32 s68, s54, 3072
  v_mov_b32 v6, 0
  v_mov_b32 v3, 0
  v_mov_b32 v4, 0
  s_waitcnt vmcnt(45)
  v_dot2c_f32_bf16 v6, v56, v16
  v_dot2c_f32_bf16 v3, v60, v20
  v_dot2c_f32_bf16 v4, v64, v24
  v_dot2c_f32_bf16 v6, v57, v17
  v_dot2c_f32_bf16 v3, v61, v21
  v_dot2c_f32_bf16 v4, v65, v25
  v_dot2c_f32_bf16 v6, v58, v18
  v_dot2c_f32_bf16 v3, v62, v22
  v_dot2c_f32_bf16 v4, v66, v26
  v_dot2c_f32_bf16 v6, v59, v19
  v_dot2c_f32_bf16 v3, v63, v23
  v_dot2c_f32_bf16 v4, v67, v27
  s_nop 1
  v_add_f32 v6, v6, v3
  v_add_f32 v6, v6, v4
  s_nop 1
  v_add_f32_dpp v6, v6, v6 quad_perm:[1,0,3,2] row_mask:0xf bank_mask:0xf
  s_nop 1
  v_add_f32_dpp v6, v6, v6 quad_perm:[2,3,0,1] row_mask:0xf bank_mask:0xf
  s_nop 1
  v_add_f32_dpp v6, v6, v6 row_half_mirror row_mask:0xf bank_mask:0xf
  v_cvt_pk_bf16_f32 v6, v6, v6
  v_lshlrev_b32 v6, 16, v6
  v_mul_f32 v6, s61, v6
  v_cvt_pk_bf16_f32 v6, v6, v6
  v_lshlrev_b32 v6, 16, v6
  buffer_load_dwordx4 v[56:59], v1, s[8:11], s54 offen offset:0 nt
  buffer_load_dwordx4 v[60:63], v1, s[8:11], s54 offen offset:128 nt
  buffer_load_dwordx4 v[64:67], v1, s[8:11], s54 offen offset:256 nt
  v_mov_b32 v7, 0
  v_mov_b32 v3, 0
  v_mov_b32 v4, 0
  s_waitcnt vmcnt(45)
  v_dot2c_f32_bf16 v7, v68, v16
  v_dot2c_f32_bf16 v3, v72, v20
  v_dot2c_f32_bf16 v4, v76, v24
  v_dot2c_f32_bf16 v7, v69, v17
  v_dot2c_f32_bf16 v3, v73, v21
  v_dot2c_f32_bf16 v4, v77, v25
  v_dot2c_f32_bf16 v7, v70, v18
  v_dot2c_f32_bf16 v3, v74, v22
  v_dot2c_f32_bf16 v4, v78, v26
  v_dot2c_f32_bf16 v7, v71, v19
  v_dot2c_f32_bf16 v3, v75, v23
  v_dot2c_f32_bf16 v4, v79, v27
  s_nop 1
  v_add_f32 v7, v7, v3
  v_add_f32 v7, v7, v4
  s_nop 1
  v_add_f32_dpp v7, v7, v7 quad_perm:[1,0,3,2] row_mask:0xf bank_mask:0xf
  s_nop 1
  v_add_f32_dpp v7, v7, v7 quad_perm:[2,3,0,1] row_mask:0xf bank_mask:0xf
  s_nop 1
  v_add_f32_dpp v7, v7, v7 row_half_mirror row_mask:0xf bank_mask:0xf
  v_cvt_pk_bf16_f32 v7, v7, v7
  v_lshlrev_b32 v7, 16, v7
  v_mul_f32 v7, s61, v7
  v_cvt_pk_bf16_f32 v7, v7, v7
  v_lshlrev_b32 v7, 16, v7
  buffer_load_dwordx4 v[68:71], v1, s[12:15], s68 offen offset:0 nt
  buffer_load_dwordx4 v[72:75], v1, s[12:15], s68 offen offset:128 nt
  buffer_load_dwordx4 v[76:79], v1, s[12:15], s68 offen offset:256 nt
  s_lshl_b32 s58, s69, 6
  v_add_u32 v5, s58, v13
  v_max3_f32 v53, v53, v6, v7
  ds_write_b64 v5, v[6:7]
  s_mov_b32 s69, s60
  s_add_u32 s60, s55, 4
  v_mov_b32 v6, 0
  v_mov_b32 v3, 0
  v_mov_b32 v4, 0
  s_waitcnt vmcnt(45)
  v_dot2c_f32_bf16 v6, v80, v16
  v_dot2c_f32_bf16 v3, v84, v20
  v_dot2c_f32_bf16 v4, v88, v24
  v_dot2c_f32_bf16 v6, v81, v17
  v_dot2c_f32_bf16 v3, v85, v21
  v_dot2c_f32_bf16 v4, v89, v25
  v_dot2c_f32_bf16 v6, v82, v18
  v_dot2c_f32_bf16 v3, v86, v22
  v_dot2c_f32_bf16 v4, v90, v26
  v_dot2c_f32_bf16 v6, v83, v19
  v_dot2c_f32_bf16 v3, v87, v23
  v_dot2c_f32_bf16 v4, v91, v27
  s_nop 1
  v_add_f32 v6, v6, v3
  v_add_f32 v6, v6, v4
  s_nop 1
  v_add_f32_dpp v6, v6, v6 quad_perm:[1,0,3,2] row_mask:0xf bank_mask:0xf
  s_nop 1
  v_add_f32_dpp v6, v6, v6 quad_perm:[2,3,0,1] row_mask:0xf bank_mask:0xf
  s_nop 1
  v_add_f32_dpp v6, v6, v6 row_half_mirror row_mask:0xf bank_mask:0xf
  v_cvt_pk_bf16_f32 v6, v6, v6
  v_lshlrev_b32 v6, 16, v6
  v_mul_f32 v6, s61, v6
  v_cvt_pk_bf16_f32 v6, v6, v6
  v_lshlrev_b32 v6, 16, v6
  v_mov_b32 v7, 0
  v_mov_b32 v3, 0
  v_mov_b32 v4, 0
  s_waitcnt vmcnt(42)
  v_dot2c_f32_bf16 v7, v92, v16
  v_dot2c_f32_bf16 v3, v96, v20
  v_dot2c_f32_bf16 v4, v100, v24
  v_dot2c_f32_bf16 v7, v93, v17
  v_dot2c_f32_bf16 v3, v97, v21
  v_dot2c_f32_bf16 v4, v101, v25
  v_dot2c_f32_bf16 v7, v94, v18
  v_dot2c_f32_bf16 v3, v98, v22
  v_dot2c_f32_bf16 v4, v102, v26
  v_dot2c_f32_bf16 v7, v95, v19
  v_dot2c_f32_bf16 v3, v99, v23
  v_dot2c_f32_bf16 v4, v103, v27
  s_nop 1
  v_add_f32 v7, v7, v3
  v_add_f32 v7, v7, v4
  s_nop 1
  v_add_f32_dpp v7, v7, v7 quad_perm:[1,0,3,2] row_mask:0xf bank_mask:0xf
  s_nop 1
  v_add_f32_dpp v7, v7, v7 quad_perm:[2,3,0,1] row_mask:0xf bank_mask:0xf
  s_nop 1
  v_add_f32_dpp v7, v7, v7 row_half_mirror row_mask:0xf bank_mask:0xf
  v_cvt_pk_bf16_f32 v7, v7, v7
  v_lshlrev_b32 v7, 16, v7
  v_mul_f32 v7, s61, v7
  v_cvt_pk_bf16_f32 v7, v7, v7
  v_lshlrev_b32 v7, 16, v7
  s_lshl_b32 s58, s60, 6
  v_add_u32 v5, s58, v13
  v_max3_f32 v53, v53, v6, v7
  ds_write_b64 v5, v[6:7]
  s_add_u32 s60, s55, 8
  v_mov_b32 v6, 0
  v_mov_b32 v3, 0
  v_mov_b32 v4, 0
  s_waitcnt vmcnt(39)
  v_dot2c_f32_bf16 v6, v104, v16
  v_dot2c_f32_bf16 v3, v108, v20
  v_dot2c_f32_bf16 v4, v112, v24
  v_dot2c_f32_bf16 v6, v105, v17
  v_dot2c_f32_bf16 v3, v109, v21
  v_dot2c_f32_bf16 v4, v113, v25
  v_dot2c_f32_bf16 v6, v106, v18
  v_dot2c_f32_bf16 v3, v110, v22
  v_dot2c_f32_bf16 v4, v114, v26
  v_dot2c_f32_bf16 v6, v107, v19
  v_dot2c_f32_bf16 v3, v111, v23
  v_dot2c_f32_bf16 v4, v115, v27
  s_nop 1
  v_add_f32 v6, v6, v3
  v_add_f32 v6, v6, v4
  s_nop 1
  v_add_f32_dpp v6, v6, v6 quad_perm:[1,0,3,2] row_mask:0xf bank_mask:0xf
  s_nop 1
  v_add_f32_dpp v6, v6, v6 quad_perm:[2,3,0,1] row_mask:0xf bank_mask:0xf
  s_nop 1
  v_add_f32_dpp v6, v6, v6 row_half_mirror row_mask:0xf bank_mask:0xf
  v_cvt_pk_bf16_f32 v6, v6, v6
  v_lshlrev_b32 v6, 16, v6
  v_mul_f32 v6, s61, v6
  v_cvt_pk_bf16_f32 v6, v6, v6
  v_lshlrev_b32 v6, 16, v6
  v_mov_b32 v7, 0
  v_mov_b32 v3, 0
  v_mov_b32 v4, 0
  s_waitcnt vmcnt(36)
  v_dot2c_f32_bf16 v7, v116, v16
  v_dot2c_f32_bf16 v3, v120, v20
  v_dot2c_f32_bf16 v4, v124, v24
  v_dot2c_f32_bf16 v7, v117, v17
  v_dot2c_f32_bf16 v3, v121, v21
  v_dot2c_f32_bf16 v4, v125, v25
  v_dot2c_f32_bf16 v7, v118, v18
  v_dot2c_f32_bf16 v3, v122, v22
  v_dot2c_f32_bf16 v4, v126, v26
  v_dot2c_f32_bf16 v7, v119, v19
  v_dot2c_f32_bf16 v3, v123, v23
  v_dot2c_f32_bf16 v4, v127, v27
  s_nop 1
  v_add_f32 v7, v7, v3
  v_add_f32 v7, v7, v4
  s_nop 1
  v_add_f32_dpp v7, v7, v7 quad_perm:[1,0,3,2] row_mask:0xf bank_mask:0xf
  s_nop 1
  v_add_f32_dpp v7, v7, v7 quad_perm:[2,3,0,1] row_mask:0xf bank_mask:0xf
  s_nop 1
  v_add_f32_dpp v7, v7, v7 row_half_mirror row_mask:0xf bank_mask:0xf
  v_cvt_pk_bf16_f32 v7, v7, v7
  v_lshlrev_b32 v7, 16, v7
  v_mul_f32 v7, s61, v7
  v_cvt_pk_bf16_f32 v7, v7, v7
  v_lshlrev_b32 v7, 16, v7
  s_lshl_b32 s58, s60, 6
  v_add_u32 v5, s58, v13
  v_max3_f32 v53, v53, v6, v7
  ds_write_b64 v5, v[6:7]
  s_add_u32 s60, s55, 36
  s_lshr_b32 s58, s60, 2
  s_mul_i32 s58, s58, s28
  s_and_b32 s59, s60, 3
  s_add_u32 s58, s58, s59
  s_add_u32 s58, s58, s30
  s_sub_u32 s59, s58, s29
  s_cselect_b32 s58, s58, s59
  s_mul_i32 s58, s58, 6144
  s_add_u32 s54, s31, s58
  s_add_u32 s68, s54, 3072
  v_mov_b32 v6, 0
  v_mov_b32 v3, 0
  v_mov_b32 v4, 0
  s_waitcnt vmcnt(3)
  v_dot2c_f32_bf16 v6, v56, v16
  v_dot2c_f32_bf16 v3, v60, v20
  v_dot2c_f32_bf16 v4, v64, v24
  v_dot2c_f32_bf16 v6, v57, v17
  v_dot2c_f32_bf16 v3, v61, v21
  v_dot2c_f32_bf16 v4, v65, v25
  v_dot2c_f32_bf16 v6, v58, v18
  v_dot2c_f32_bf16 v3, v62, v22
  v_dot2c_f32_bf16 v4, v66, v26
  v_dot2c_f32_bf16 v6, v59, v19
  v_dot2c_f32_bf16 v3, v63, v23
  v_dot2c_f32_bf16 v4, v67, v27
  s_nop 1
  v_add_f32 v6, v6, v3
  v_add_f32 v6, v6, v4
  s_nop 1
  v_add_f32_dpp v6, v6, v6 quad_perm:[1,0,3,2] row_mask:0xf bank_mask:0xf
  s_nop 1
  v_add_f32_dpp v6, v6, v6 quad_perm:[2,3,0,1] row_mask:0xf bank_mask:0xf
  s_nop 1
  v_add_f32_dpp v6, v6, v6 row_half_mirror row_mask:0xf bank_mask:0xf
  v_cvt_pk_bf16_f32 v6, v6, v6
  v_lshlrev_b32 v6, 16, v6
  v_mul_f32 v6, s61, v6
  v_cvt_pk_bf16_f32 v6, v6, v6
  v_lshlrev_b32 v6, 16, v6
  buffer_load_dwordx4 v[56:59], v1, s[8:11], s54 offen offset:0 nt
  buffer_load_dwordx4 v[60:63], v1, s[8:11], s54 offen offset:128 nt
  buffer_load_dwordx4 v[64:67], v1, s[8:11], s54 offen offset:256 nt
  v_mov_b32 v7, 0
  v_mov_b32 v3, 0
  v_mov_b32 v4, 0
  s_waitcnt vmcnt(3)
  v_dot2c_f32_bf16 v7, v68, v16
  v_dot2c_f32_bf16 v3, v72, v20
  v_dot2c_f32_bf16 v4, v76, v24
  v_dot2c_f32_bf16 v7, v69, v17
  v_dot2c_f32_bf16 v3, v73, v21
  v_dot2c_f32_bf16 v4, v77, v25
  v_dot2c_f32_bf16 v7, v70, v18
  v_dot2c_f32_bf16 v3, v74, v22
  v_dot2c_f32_bf16 v4, v78, v26
  v_dot2c_f32_bf16 v7, v71, v19
  v_dot2c_f32_bf16 v3, v75, v23
  v_dot2c_f32_bf16 v4, v79, v27
  s_nop 1
  v_add_f32 v7, v7, v3
  v_add_f32 v7, v7, v4
  s_nop 1
  v_add_f32_dpp v7, v7, v7 quad_perm:[1,0,3,2] row_mask:0xf bank_mask:0xf
  s_nop 1
  v_add_f32_dpp v7, v7, v7 quad_perm:[2,3,0,1] row_mask:0xf bank_mask:0xf
  s_nop 1
  v_add_f32_dpp v7, v7, v7 row_half_mirror row_mask:0xf bank_mask:0xf
  v_cvt_pk_bf16_f32 v7, v7, v7
  v_lshlrev_b32 v7, 16, v7
  v_mul_f32 v7, s61, v7
  v_cvt_pk_bf16_f32 v7, v7, v7
  v_lshlrev_b32 v7, 16, v7
  buffer_load_dwordx4 v[68:71], v1, s[12:15], s68 offen offset:0 nt
  buffer_load_dwordx4 v[72:75], v1, s[12:15], s68 offen offset:128 nt
  buffer_load_dwordx4 v[76:79], v1, s[12:15], s68 offen offset:256 nt
  s_lshl_b32 s58, s69, 6
  v_add_u32 v5, s58, v13
  v_max3_f32 v53, v53, v6, v7
  ds_write_b64 v5, v[6:7]
  s_mov_b32 s69, s60
  s_add_u32 s60, s55, 12
  v_mov_b32 v6, 0
  v_mov_b32 v3, 0
  v_mov_b32 v4, 0
  s_waitcnt vmcnt(39)
  v_dot2c_f32_bf16 v6, v128, v16
  v_dot2c_f32_bf16 v3, v132, v20
  v_dot2c_f32_bf16 v4, v136, v24
  v_dot2c_f32_bf16 v6, v129, v17
  v_dot2c_f32_bf16 v3, v133, v21
  v_dot2c_f32_bf16 v4, v137, v25
  v_dot2c_f32_bf16 v6, v130, v18
  v_dot2c_f32_bf16 v3, v134, v22
  v_dot2c_f32_bf16 v4, v138, v26
  v_dot2c_f32_bf16 v6, v131, v19
  v_dot2c_f32_bf16 v3, v135, v23
  v_dot2c_f32_bf16 v4, v139, v27
  s_nop 1
  v_add_f32 v6, v6, v3
  v_add_f32 v6, v6, v4
  s_nop 1
  v_add_f32_dpp v6, v6, v6 quad_perm:[1,0,3,2] row_mask:0xf bank_mask:0xf
  s_nop 1
  v_add_f32_dpp v6, v6, v6 quad_perm:[2,3,0,1] row_mask:0xf bank_mask:0xf
  s_nop 1
  v_add_f32_dpp v6, v6, v6 row_half_mirror row_mask:0xf bank_mask:0xf
  v_cvt_pk_bf16_f32 v6, v6, v6
  v_lshlrev_b32 v6, 16, v6
  v_mul_f32 v6, s61, v6
  v_cvt_pk_bf16_f32 v6, v6, v6
  v_lshlrev_b32 v6, 16, v6
  v_mov_b32 v7, 0
  v_mov_b32 v3, 0
  v_mov_b32 v4, 0
  s_waitcnt vmcnt(36)
  v_dot2c_f32_bf16 v7, v140, v16
  v_dot2c_f32_bf16 v3, v144, v20
  v_dot2c_f32_bf16 v4, v148, v24
  v_dot2c_f32_bf16 v7, v141, v17
  v_dot2c_f32_bf16 v3, v145, v21
  v_dot2c_f32_bf16 v4, v149, v25
  v_dot2c_f32_bf16 v7, v142, v18
  v_dot2c_f32_bf16 v3, v146, v22
  v_dot2c_f32_bf16 v4, v150, v26
  v_dot2c_f32_bf16 v7, v143, v19
  v_dot2c_f32_bf16 v3, v147, v23
  v_dot2c_f32_bf16 v4, v151, v27
  s_nop 1
  v_add_f32 v7, v7, v3
  v_add_f32 v7, v7, v4
  s_nop 1
  v_add_f32_dpp v7, v7, v7 quad_perm:[1,0,3,2] row_mask:0xf bank_mask:0xf
  s_nop 1
  v_add_f32_dpp v7, v7, v7 quad_perm:[2,3,0,1] row_mask:0xf bank_mask:0xf
  s_nop 1
  v_add_f32_dpp v7, v7, v7 row_half_mirror row_mask:0xf bank_mask:0xf
  v_cvt_pk_bf16_f32 v7, v7, v7
  v_lshlrev_b32 v7, 16, v7
  v_mul_f32 v7, s61, v7
  v_cvt_pk_bf16_f32 v7, v7, v7
  v_lshlrev_b32 v7, 16, v7
  s_lshl_b32 s58, s60, 6
  v_add_u32 v5, s58, v13
  v_max3_f32 v53, v53, v6, v7
  ds_write_b64 v5, v[6:7]
  s_add_u32 s60, s55, 16
  v_mov_b32 v6, 0
  v_mov_b32 v3, 0
  v_mov_b32 v4, 0
  s_waitcnt vmcnt(33)
  v_dot2c_f32_bf16 v6, v152, v16
  v_dot2c_f32_bf16 v3, v156, v20
  v_dot2c_f32_bf16 v4, v160, v24
  v_dot2c_f32_bf16 v6, v153, v17
  v_dot2c_f32_bf16 v3, v157, v21
  v_dot2c_f32_bf16 v4, v161, v25
  v_dot2c_f32_bf16 v6, v154, v18
  v_dot2c_f32_bf16 v3, v158, v22
  v_dot2c_f32_bf16 v4, v162, v26
  v_dot2c_f32_bf16 v6, v155, v19
  v_dot2c_f32_bf16 v3, v159, v23
  v_dot2c_f32_bf16 v4, v163, v27
  s_nop 1
  v_add_f32 v6, v6, v3
  v_add_f32 v6, v6, v4
  s_nop 1
  v_add_f32_dpp v6, v6, v6 quad_perm:[1,0,3,2] row_mask:0xf bank_mask:0xf
  s_nop 1
  v_add_f32_dpp v6, v6, v6 quad_perm:[2,3,0,1] row_mask:0xf bank_mask:0xf
  s_nop 1
  v_add_f32_dpp v6, v6, v6 row_half_mirror row_mask:0xf bank_mask:0xf
  v_cvt_pk_bf16_f32 v6, v6, v6
  v_lshlrev_b32 v6, 16, v6
  v_mul_f32 v6, s61, v6
  v_cvt_pk_bf16_f32 v6, v6, v6
  v_lshlrev_b32 v6, 16, v6
  v_mov_b32 v7, 0
  v_mov_b32 v3, 0
  v_mov_b32 v4, 0
  s_waitcnt vmcnt(30)
  v_dot2c_f32_bf16 v7, v164, v16
  v_dot2c_f32_bf16 v3, v168, v20
  v_dot2c_f32_bf16 v4, v172, v24
  v_dot2c_f32_bf16 v7, v165, v17
  v_dot2c_f32_bf16 v3, v169, v21
  v_dot2c_f32_bf16 v4, v173, v25
  v_dot2c_f32_bf16 v7, v166, v18
  v_dot2c_f32_bf16 v3, v170, v22
  v_dot2c_f32_bf16 v4, v174, v26
  v_dot2c_f32_bf16 v7, v167, v19
  v_dot2c_f32_bf16 v3, v171, v23
  v_dot2c_f32_bf16 v4, v175, v27
  s_nop 1
  v_add_f32 v7, v7, v3
  v_add_f32 v7, v7, v4
  s_nop 1
  v_add_f32_dpp v7, v7, v7 quad_perm:[1,0,3,2] row_mask:0xf bank_mask:0xf
  s_nop 1
  v_add_f32_dpp v7, v7, v7 quad_perm:[2,3,0,1] row_mask:0xf bank_mask:0xf
  s_nop 1
  v_add_f32_dpp v7, v7, v7 row_half_mirror row_mask:0xf bank_mask:0xf
  v_cvt_pk_bf16_f32 v7, v7, v7
  v_lshlrev_b32 v7, 16, v7
  v_mul_f32 v7, s61, v7
  v_cvt_pk_bf16_f32 v7, v7, v7
  v_lshlrev_b32 v7, 16, v7
  s_lshl_b32 s58, s60, 6
  v_add_u32 v5, s58, v13
  v_max3_f32 v53, v53, v6, v7
  ds_write_b64 v5, v[6:7]
  s_add_u32 s60, s55, 40
  s_lshr_b32 s58, s60, 2
  s_mul_i32 s58, s58, s28
  s_and_b32 s59, s60, 3
  s_add_u32 s58, s58, s59
  s_add_u32 s58, s58, s30
  s_sub_u32 s59, s58, s29
  s_cselect_b32 s58, s58, s59
  s_mul_i32 s58, s58, 6144
  s_add_u32 s54, s31, s58
  s_add_u32 s68, s54, 3072
  v_mov_b32 v6, 0
  v_mov_b32 v3, 0
  v_mov_b32 v4, 0
  s_waitcnt vmcnt(3)
  v_dot2c_f32_bf16 v6, v56, v16
  v_dot2c_f32_bf16 v3, v60, v20
  v_dot2c_f32_bf16 v4, v64, v24
  v_dot2c_f32_bf16 v6, v57, v17
  v_dot2c_f32_bf16 v3, v61, v21
  v_dot2c_f32_bf16 v4, v65, v25
  v_dot2c_f32_bf16 v6, v58, v18
  v_dot2c_f32_bf16 v3, v62, v22
  v_dot2c_f32_bf16 v4, v66, v26
  v_dot2c_f32_bf16 v6, v59, v19
  v_dot2c_f32_bf16 v3, v63, v23
  v_dot2c_f32_bf16 v4, v67, v27
  s_nop 1
  v_add_f32 v6, v6, v3
  v_add_f32 v6, v6, v4
  s_nop 1
  v_add_f32_dpp v6, v6, v6 quad_perm:[1,0,3,2] row_mask:0xf bank_mask:0xf
  s_nop 1
  v_add_f32_dpp v6, v6, v6 quad_perm:[2,3,0,1] row_mask:0xf bank_mask:0xf
  s_nop 1
  v_add_f32_dpp v6, v6, v6 row_half_mirror row_mask:0xf bank_mask:0xf
  v_cvt_pk_bf16_f32 v6, v6, v6
  v_lshlrev_b32 v6, 16, v6
  v_mul_f32 v6, s61, v6
  v_cvt_pk_bf16_f32 v6, v6, v6
  v_lshlrev_b32 v6, 16, v6
  buffer_load_dwordx4 v[56:59], v1, s[8:11], s54 offen offset:0 nt
  buffer_load_dwordx4 v[60:63], v1, s[8:11], s54 offen offset:128 nt
  buffer_load_dwordx4 v[64:67], v1, s[8:11], s54 offen offset:256 nt
  v_mov_b32 v7, 0
  v_mov_b32 v3, 0
  v_mov_b32 v4, 0
  s_waitcnt vmcnt(3)
  v_dot2c_f32_bf16 v7, v68, v16
  v_dot2c_f32_bf16 v3, v72, v20
  v_dot2c_f32_bf16 v4, v76, v24
  v_dot2c_f32_bf16 v7, v69, v17
  v_dot2c_f32_bf16 v3, v73, v21
  v_dot2c_f32_bf16 v4, v77, v25
  v_dot2c_f32_bf16 v7, v70, v18
  v_dot2c_f32_bf16 v3, v74, v22
  v_dot2c_f32_bf16 v4, v78, v26
  v_dot2c_f32_bf16 v7, v71, v19
  v_dot2c_f32_bf16 v3, v75, v23
  v_dot2c_f32_bf16 v4, v79, v27
  s_nop 1
  v_add_f32 v7, v7, v3
  v_add_f32 v7, v7, v4
  s_nop 1
  v_add_f32_dpp v7, v7, v7 quad_perm:[1,0,3,2] row_mask:0xf bank_mask:0xf
  s_nop 1
  v_add_f32_dpp v7, v7, v7 quad_perm:[2,3,0,1] row_mask:0xf bank_mask:0xf
  s_nop 1
  v_add_f32_dpp v7, v7, v7 row_half_mirror row_mask:0xf bank_mask:0xf
  v_cvt_pk_bf16_f32 v7, v7, v7
  v_lshlrev_b32 v7, 16, v7
  v_mul_f32 v7, s61, v7
  v_cvt_pk_bf16_f32 v7, v7, v7
  v_lshlrev_b32 v7, 16, v7
  buffer_load_dwordx4 v[68:71], v1, s[12:15], s68 offen offset:0 nt
  buffer_load_dwordx4 v[72:75], v1, s[12:15], s68 offen offset:128 nt
  buffer_load_dwordx4 v[76:79], v1, s[12:15], s68 offen offset:256 nt
  s_lshl_b32 s58, s69, 6
  v_add_u32 v5, s58, v13
  v_max3_f32 v53, v53, v6, v7
  ds_write_b64 v5, v[6:7]
  s_mov_b32 s69, s60
  s_add_u32 s60, s55, 20
  v_mov_b32 v6, 0
  v_mov_b32 v3, 0
  v_mov_b32 v4, 0
  s_waitcnt vmcnt(33)
  v_dot2c_f32_bf16 v6, v176, v16
  v_dot2c_f32_bf16 v3, v180, v20
  v_dot2c_f32_bf16 v4, v184, v24
  v_dot2c_f32_bf16 v6, v177, v17
  v_dot2c_f32_bf16 v3, v181, v21
  v_dot2c_f32_bf16 v4, v185, v25
  v_dot2c_f32_bf16 v6, v178, v18
  v_dot2c_f32_bf16 v3, v182, v22
  v_dot2c_f32_bf16 v4, v186, v26
  v_dot2c_f32_bf16 v6, v179, v19
  v_dot2c_f32_bf16 v3, v183, v23
  v_dot2c_f32_bf16 v4, v187, v27
  s_nop 1
  v_add_f32 v6, v6, v3
  v_add_f32 v6, v6, v4
  s_nop 1
  v_add_f32_dpp v6, v6, v6 quad_perm:[1,0,3,2] row_mask:0xf bank_mask:0xf
  s_nop 1
  v_add_f32_dpp v6, v6, v6 quad_perm:[2,3,0,1] row_mask:0xf bank_mask:0xf
  s_nop 1
  v_add_f32_dpp v6, v6, v6 row_half_mirror row_mask:0xf bank_mask:0xf
  v_cvt_pk_bf16_f32 v6, v6, v6
  v_lshlrev_b32 v6, 16, v6
  v_mul_f32 v6, s61, v6
  v_cvt_pk_bf16_f32 v6, v6, v6
  v_lshlrev_b32 v6, 16, v6
  v_mov_b32 v7, 0
  v_mov_b32 v3, 0
  v_mov_b32 v4, 0
  s_waitcnt vmcnt(30)
  v_dot2c_f32_bf16 v7, v188, v16
  v_dot2c_f32_bf16 v3, v192, v20
  v_dot2c_f32_bf16 v4, v196, v24
  v_dot2c_f32_bf16 v7, v189, v17
  v_dot2c_f32_bf16 v3, v193, v21
  v_dot2c_f32_bf16 v4, v197, v25
  v_dot2c_f32_bf16 v7, v190, v18
  v_dot2c_f32_bf16 v3, v194, v22
  v_dot2c_f32_bf16 v4, v198, v26
  v_dot2c_f32_bf16 v7, v191, v19
  v_dot2c_f32_bf16 v3, v195, v23
  v_dot2c_f32_bf16 v4, v199, v27
  s_nop 1
  v_add_f32 v7, v7, v3
  v_add_f32 v7, v7, v4
  s_nop 1
  v_add_f32_dpp v7, v7, v7 quad_perm:[1,0,3,2] row_mask:0xf bank_mask:0xf
  s_nop 1
  v_add_f32_dpp v7, v7, v7 quad_perm:[2,3,0,1] row_mask:0xf bank_mask:0xf
  s_nop 1
  v_add_f32_dpp v7, v7, v7 row_half_mirror row_mask:0xf bank_mask:0xf
  v_cvt_pk_bf16_f32 v7, v7, v7
  v_lshlrev_b32 v7, 16, v7
  v_mul_f32 v7, s61, v7
  v_cvt_pk_bf16_f32 v7, v7, v7
  v_lshlrev_b32 v7, 16, v7
  s_lshl_b32 s58, s60, 6
  v_add_u32 v5, s58, v13
  v_max3_f32 v53, v53, v6, v7
  ds_write_b64 v5, v[6:7]
  s_add_u32 s60, s55, 24
  v_mov_b32 v6, 0
  v_mov_b32 v3, 0
  v_mov_b32 v4, 0
  s_waitcnt vmcnt(27)
  v_dot2c_f32_bf16 v6, v200, v16
  v_dot2c_f32_bf16 v3, v204, v20
  v_dot2c_f32_bf16 v4, v208, v24
  v_dot2c_f32_bf16 v6, v201, v17
  v_dot2c_f32_bf16 v3, v205, v21
  v_dot2c_f32_bf16 v4, v209, v25
  v_dot2c_f32_bf16 v6, v202, v18
  v_dot2c_f32_bf16 v3, v206, v22
  v_dot2c_f32_bf16 v4, v210, v26
  v_dot2c_f32_bf16 v6, v203, v19
  v_dot2c_f32_bf16 v3, v207, v23
  v_dot2c_f32_bf16 v4, v211, v27
  s_nop 1
  v_add_f32 v6, v6, v3
  v_add_f32 v6, v6, v4
  s_nop 1
  v_add_f32_dpp v6, v6, v6 quad_perm:[1,0,3,2] row_mask:0xf bank_mask:0xf
  s_nop 1
  v_add_f32_dpp v6, v6, v6 quad_perm:[2,3,0,1] row_mask:0xf bank_mask:0xf
  s_nop 1
  v_add_f32_dpp v6, v6, v6 row_half_mirror row_mask:0xf bank_mask:0xf
  v_cvt_pk_bf16_f32 v6, v6, v6
  v_lshlrev_b32 v6, 16, v6
  v_mul_f32 v6, s61, v6
  v_cvt_pk_bf16_f32 v6, v6, v6
  v_lshlrev_b32 v6, 16, v6
  v_mov_b32 v7, 0
  v_mov_b32 v3, 0
  v_mov_b32 v4, 0
  s_waitcnt vmcnt(24)
  v_dot2c_f32_bf16 v7, v212, v16
  v_dot2c_f32_bf16 v3, v216, v20
  v_dot2c_f32_bf16 v4, v220, v24
  v_dot2c_f32_bf16 v7, v213, v17
  v_dot2c_f32_bf16 v3, v217, v21
  v_dot2c_f32_bf16 v4, v221, v25
  v_dot2c_f32_bf16 v7, v214, v18
  v_dot2c_f32_bf16 v3, v218, v22
  v_dot2c_f32_bf16 v4, v222, v26
  v_dot2c_f32_bf16 v7, v215, v19
  v_dot2c_f32_bf16 v3, v219, v23
  v_dot2c_f32_bf16 v4, v223, v27
  s_nop 1
  v_add_f32 v7, v7, v3
  v_add_f32 v7, v7, v4
  s_nop 1
  v_add_f32_dpp v7, v7, v7 quad_perm:[1,0,3,2] row_mask:0xf bank_mask:0xf
  s_nop 1
  v_add_f32_dpp v7, v7, v7 quad_perm:[2,3,0,1] row_mask:0xf bank_mask:0xf
  s_nop 1
  v_add_f32_dpp v7, v7, v7 row_half_mirror row_mask:0xf bank_mask:0xf
  v_cvt_pk_bf16_f32 v7, v7, v7
  v_lshlrev_b32 v7, 16, v7
  v_mul_f32 v7, s61, v7
  v_cvt_pk_bf16_f32 v7, v7, v7
  v_lshlrev_b32 v7, 16, v7
  s_lshl_b32 s58, s60, 6
  v_add_u32 v5, s58, v13
  v_max3_f32 v53, v53, v6, v7
  ds_write_b64 v5, v[6:7]
  s_add_u32 s60, s55, 44
  s_lshr_b32 s58, s60, 2
  s_mul_i32 s58, s58, s28
  s_and_b32 s59, s60, 3
  s_add_u32 s58, s58, s59
  s_add_u32 s58, s58, s30
  s_sub_u32 s59, s58, s29
  s_cselect_b32 s58, s58, s59
  s_mul_i32 s58, s58, 6144
  s_add_u32 s54, s31, s58
  s_add_u32 s68, s54, 3072
  v_mov_b32 v6, 0
  v_mov_b32 v3, 0
  v_mov_b32 v4, 0
  s_waitcnt vmcnt(3)
  v_dot2c_f32_bf16 v6, v56, v16
  v_dot2c_f32_bf16 v3, v60, v20
  v_dot2c_f32_bf16 v4, v64, v24
  v_dot2c_f32_bf16 v6, v57, v17
  v_dot2c_f32_bf16 v3, v61, v21
  v_dot2c_f32_bf16 v4, v65, v25
  v_dot2c_f32_bf16 v6, v58, v18
  v_dot2c_f32_bf16 v3, v62, v22
  v_dot2c_f32_bf16 v4, v66, v26
  v_dot2c_f32_bf16 v6, v59, v19
  v_dot2c_f32_bf16 v3, v63, v23
  v_dot2c_f32_bf16 v4, v67, v27
  s_nop 1
  v_add_f32 v6, v6, v3
  v_add_f32 v6, v6, v4
  s_nop 1
  v_add_f32_dpp v6, v6, v6 quad_perm:[1,0,3,2] row_mask:0xf bank_mask:0xf
  s_nop 1
  v_add_f32_dpp v6, v6, v6 quad_perm:[2,3,0,1] row_mask:0xf bank_mask:0xf
  s_nop 1
  v_add_f32_dpp v6, v6, v6 row_half_mirror row_mask:0xf bank_mask:0xf
  v_cvt_pk_bf16_f32 v6, v6, v6
  v_lshlrev_b32 v6, 16, v6
  v_mul_f32 v6, s61, v6
  v_cvt_pk_bf16_f32 v6, v6, v6
  v_lshlrev_b32 v6, 16, v6
  buffer_load_dwordx4 v[56:59], v1, s[8:11], s54 offen offset:0 nt
  buffer_load_dwordx4 v[60:63], v1, s[8:11], s54 offen offset:128 nt
  buffer_load_dwordx4 v[64:67], v1, s[8:11], s54 offen offset:256 nt
  v_mov_b32 v7, 0
  v_mov_b32 v3, 0
  v_mov_b32 v4, 0
  s_waitcnt vmcnt(3)
  v_dot2c_f32_bf16 v7, v68, v16
  v_dot2c_f32_bf16 v3, v72, v20
  v_dot2c_f32_bf16 v4, v76, v24
  v_dot2c_f32_bf16 v7, v69, v17
  v_dot2c_f32_bf16 v3, v73, v21
  v_dot2c_f32_bf16 v4, v77, v25
  v_dot2c_f32_bf16 v7, v70, v18
  v_dot2c_f32_bf16 v3, v74, v22
  v_dot2c_f32_bf16 v4, v78, v26
  v_dot2c_f32_bf16 v7, v71, v19
  v_dot2c_f32_bf16 v3, v75, v23
  v_dot2c_f32_bf16 v4, v79, v27
  s_nop 1
  v_add_f32 v7, v7, v3
  v_add_f32 v7, v7, v4
  s_nop 1
  v_add_f32_dpp v7, v7, v7 quad_perm:[1,0,3,2] row_mask:0xf bank_mask:0xf
  s_nop 1
  v_add_f32_dpp v7, v7, v7 quad_perm:[2,3,0,1] row_mask:0xf bank_mask:0xf
  s_nop 1
  v_add_f32_dpp v7, v7, v7 row_half_mirror row_mask:0xf bank_mask:0xf
  v_cvt_pk_bf16_f32 v7, v7, v7
  v_lshlrev_b32 v7, 16, v7
  v_mul_f32 v7, s61, v7
  v_cvt_pk_bf16_f32 v7, v7, v7
  v_lshlrev_b32 v7, 16, v7
  buffer_load_dwordx4 v[68:71], v1, s[12:15], s68 offen offset:0 nt
  buffer_load_dwordx4 v[72:75], v1, s[12:15], s68 offen offset:128 nt
  buffer_load_dwordx4 v[76:79], v1, s[12:15], s68 offen offset:256 nt
  s_lshl_b32 s58, s69, 6
  v_add_u32 v5, s58, v13
  v_max3_f32 v53, v53, v6, v7
  ds_write_b64 v5, v[6:7]
  s_mov_b32 s69, s60
  s_add_u32 s60, s55, 28
  v_mov_b32 v6, 0
  v_mov_b32 v3, 0
  v_mov_b32 v4, 0
  s_waitcnt vmcnt(27)
  v_dot2c_f32_bf16 v6, v224, v16
  v_dot2c_f32_bf16 v3, v228, v20
  v_dot2c_f32_bf16 v4, v232, v24
  v_dot2c_f32_bf16 v6, v225, v17
  v_dot2c_f32_bf16 v3, v229, v21
  v_dot2c_f32_bf16 v4, v233, v25
  v_dot2c_f32_bf16 v6, v226, v18
  v_dot2c_f32_bf16 v3, v230, v22
  v_dot2c_f32_bf16 v4, v234, v26
  v_dot2c_f32_bf16 v6, v227, v19
  v_dot2c_f32_bf16 v3, v231, v23
  v_dot2c_f32_bf16 v4, v235, v27
  s_nop 1
  v_add_f32 v6, v6, v3
  v_add_f32 v6, v6, v4
  s_nop 1
  v_add_f32_dpp v6, v6, v6 quad_perm:[1,0,3,2] row_mask:0xf bank_mask:0xf
  s_nop 1
  v_add_f32_dpp v6, v6, v6 quad_perm:[2,3,0,1] row_mask:0xf bank_mask:0xf
  s_nop 1
  v_add_f32_dpp v6, v6, v6 row_half_mirror row_mask:0xf bank_mask:0xf
  v_cvt_pk_bf16_f32 v6, v6, v6
  v_lshlrev_b32 v6, 16, v6
  v_mul_f32 v6, s61, v6
  v_cvt_pk_bf16_f32 v6, v6, v6
  v_lshlrev_b32 v6, 16, v6
  v_mov_b32 v7, 0
  v_mov_b32 v3, 0
  v_mov_b32 v4, 0
  s_waitcnt vmcnt(24)
  v_dot2c_f32_bf16 v7, v236, v16
  v_dot2c_f32_bf16 v3, v240, v20
  v_dot2c_f32_bf16 v4, v244, v24
  v_dot2c_f32_bf16 v7, v237, v17
  v_dot2c_f32_bf16 v3, v241, v21
  v_dot2c_f32_bf16 v4, v245, v25
  v_dot2c_f32_bf16 v7, v238, v18
  v_dot2c_f32_bf16 v3, v242, v22
  v_dot2c_f32_bf16 v4, v246, v26
  v_dot2c_f32_bf16 v7, v239, v19
  v_dot2c_f32_bf16 v3, v243, v23
  v_dot2c_f32_bf16 v4, v247, v27
  s_nop 1
  v_add_f32 v7, v7, v3
  v_add_f32 v7, v7, v4
  s_nop 1
  v_add_f32_dpp v7, v7, v7 quad_perm:[1,0,3,2] row_mask:0xf bank_mask:0xf
  s_nop 1
  v_add_f32_dpp v7, v7, v7 quad_perm:[2,3,0,1] row_mask:0xf bank_mask:0xf
  s_nop 1
  v_add_f32_dpp v7, v7, v7 row_half_mirror row_mask:0xf bank_mask:0xf
  v_cvt_pk_bf16_f32 v7, v7, v7
  v_lshlrev_b32 v7, 16, v7
  v_mul_f32 v7, s61, v7
  v_cvt_pk_bf16_f32 v7, v7, v7
  v_lshlrev_b32 v7, 16, v7
  s_lshl_b32 s58, s60, 6
  v_add_u32 v5, s58, v13
  v_max3_f32 v53, v53, v6, v7
  ds_write_b64 v5, v[6:7]
  s_mov_b32 s16, 0
  s_mov_b32 s19, 0
  s_mov_b32 s24, 48
  s_mov_b32 s25, 48
  s_mov_b32 s26, 0
  s_mov_b32 s17, s69
  s_mov_b32 s39, s36
L_p1:
  s_mov_b32 s18, s17
  s_waitcnt lgkmcnt(0)
  v_readfirstlane_b32 s55, v55
  s_cmp_lt_u32 s55, s25
  s_cbranch_scc1 L_nsw1
  s_call_b64 s[98:99], L_rot
L_nsw1:
  s_mov_b32 s60, s55
  s_cmp_ge_u32 s55, s37
  s_cbranch_scc1 L_p1x
L_p1b:
  s_add_u32 s60, s60, s16
  s_cmp_ge_u32 s60, s24
  s_cselect_b32 s17, s19, 0
  s_sub_u32 s60, s60, s17
  s_mov_b32 s17, s60
  s_sub_u32 s58, s60, s36
  s_cmp_lt_u32 s60, s36
  s_cselect_b32 s60, s60, s58
  s_cselect_b32 s68, 0, s57
  s_cselect_b64 s[40:41], s[28:29], s[32:33]
  s_cselect_b64 s[42:43], s[30:31], s[34:35]
  s_lshr_b32 s58, s60, 2
  s_max_u32 s59, s58, 11
  s_sub_u32 s59, s59, 11
  s_mul_i32 s59, s59, s68
  s_mul_i32 s58, s58, s40
  s_sub_u32 s58, s58, s59
  s_and_b32 s59, s60, 3
  s_add_u32 s58, s58, s59
  s_add_u32 s58, s58, s42
  s_sub_u32 s59, s58, s41
  s_cselect_b32 s58, s58, s59
  s_mul_i32 s58, s58, 6144
  s_add_u32 s54, s43, s58
  s_add_u32 s68, s54, 3072
  s_mov_b64 exec, 1
  ds_add_rtn_u32 v55, v14, v15 offset:10304
  s_mov_b64 exec, -1
  v_mov_b32 v6, 0
  v_mov_b32 v3, 0
  v_mov_b32 v4, 0
  s_waitcnt vmcnt(3)
  v_dot2c_f32_bf16 v6, v56, v16
  v_dot2c_f32_bf16 v3, v60, v20
  v_dot2c_f32_bf16 v4, v64, v24
  v_dot2c_f32_bf16 v6, v57, v17
  v_dot2c_f32_bf16 v3, v61, v21
  v_dot2c_f32_bf16 v4, v65, v25
  v_dot2c_f32_bf16 v6, v58, v18
  v_dot2c_f32_bf16 v3, v62, v22
  v_dot2c_f32_bf16 v4, v66, v26
  v_dot2c_f32_bf16 v6, v59, v19
  v_dot2c_f32_bf16 v3, v63, v23
  v_dot2c_f32_bf16 v4, v67, v27
  s_nop 1
  v_add_f32 v6, v6, v3
  v_add_f32 v6, v6, v4
  s_nop 1
  v_add_f32_dpp v6, v6, v6 quad_perm:[1,0,3,2] row_mask:0xf bank_mask:0xf
  s_nop 1
  v_add_f32_dpp v6, v6, v6 quad_perm:[2,3,0,1] row_mask:0xf bank_mask:0xf
  s_nop 1
  v_add_f32_dpp v6, v6, v6 row_half_mirror row_mask:0xf bank_mask:0xf
  v_cvt_pk_bf16_f32 v6, v6, v6
  v_lshlrev_b32 v6, 16, v6
  v_mul_f32 v6, s61, v6
  v_cvt_pk_bf16_f32 v6, v6, v6
  v_lshlrev_b32 v6, 16, v6
  buffer_load_dwordx4 v[56:59], v1, s[8:11], s54 offen offset:0 nt
  buffer_load_dwordx4 v[60:63], v1, s[8:11], s54 offen offset:128 nt
  buffer_load_dwordx4 v[64:67], v1, s[8:11], s54 offen offset:256 nt
  v_mov_b32 v7, 0
  v_mov_b32 v3, 0
  v_mov_b32 v4, 0
  s_waitcnt vmcnt(3)
  v_dot2c_f32_bf16 v7, v68, v16
  v_dot2c_f32_bf16 v3, v72, v20
  v_dot2c_f32_bf16 v4, v76, v24
  v_dot2c_f32_bf16 v7, v69, v17
  v_dot2c_f32_bf16 v3, v73, v21
  v_dot2c_f32_bf16 v4, v77, v25
  v_dot2c_f32_bf16 v7, v70, v18
  v_dot2c_f32_bf16 v3, v74, v22
  v_dot2c_f32_bf16 v4, v78, v26
  v_dot2c_f32_bf16 v7, v71, v19
  v_dot2c_f32_bf16 v3, v75, v23
  v_dot2c_f32_bf16 v4, v79, v27
  s_nop 1
  v_add_f32 v7, v7, v3
  v_add_f32 v7, v7, v4
  s_nop 1
  v_add_f32_dpp v7, v7, v7 quad_perm:[1,0,3,2] row_mask:0xf bank_mask:0xf
  s_nop 1
  v_add_f32_dpp v7, v7, v7 quad_perm:[2,3,0,1] row_mask:0xf bank_mask:0xf
  s_nop 1
  v_add_f32_dpp v7, v7, v7 row_half_mirror row_mask:0xf bank_mask:0xf
  v_cvt_pk_bf16_f32 v7, v7, v7
  v_lshlrev_b32 v7, 16, v7
  v_mul_f32 v7, s61, v7
  v_cvt_pk_bf16_f32 v7, v7, v7
  v_lshlrev_b32 v7, 16, v7
  buffer_load_dwordx4 v[68:71], v1, s[12:15], s68 offen offset:0 nt
  buffer_load_dwordx4 v[72:75], v1, s[12:15], s68 offen offset:128 nt
  buffer_load_dwordx4 v[76:79], v1, s[12:15], s68 offen offset:256 nt
  s_lshl_b32 s58, s18, 6
  v_add_u32 v5, s58, v13
  v_max3_f32 v53, v53, v6, v7
  ds_write_b64 v5, v[6:7]
  s_mov_b32 s69, s55
L_p1c:
  s_cmp_lt_u32 s55, s39
  s_cbranch_scc1 L_p1
  s_cmp_lg_u32 s39, s37
  s_cbranch_scc1 L_p1s
  v_max_f32_dpp v248, v248, v248 row_ror:8 row_mask:0xf bank_mask:0xf
  v_max_f32_dpp v53, v53, v53 row_ror:8 row_mask:0xf bank_mask:0xf
  v_mov_b32 v3, v248
  v_mov_b32 v4, v53
  s_nop 0
  v_permlane16_swap_b32 v248, v3
  v_permlane16_swap_b32 v53, v4
  v_max_f32 v248, v248, v3
  v_max_f32 v53, v53, v4
  v_mov_b32 v3, v248
  v_mov_b32 v4, v53
  s_nop 0
  v_permlane32_swap_b32 v248, v3
  v_permlane32_swap_b32 v53, v4
  v_max_f32 v248, v248, v3
  v_max_f32 v53, v53, v4
  v_mov_b32 v249, v53
  s_lshl_b32 s58, s3, 3
  v_mov_b32 v3, s58
  ds_write_b64 v3, v[248:249] offset:10304
  s_mov_b64 exec, 1
  ds_add_u32 v14, v15 offset:10312
  s_mov_b64 exec, -1
L_kw:
  ds_read_b32 v3, v14 offset:10312
  ds_read_b128 v[80:83], v14 offset:10336
  ds_read_b128 v[84:87], v14 offset:10352
  s_waitcnt lgkmcnt(0)
  v_readfirstlane_b32 s58, v3
  s_cmp_lt_u32 s58, 4
  s_cbranch_scc1 L_kw
  v_max3_f32 v248, v80, v82, v84
  v_max3_f32 v53, v81, v83, v85
  v_max_f32 v248, v248, v86
  v_max_f32 v53, v53, v87
  v_mul_f32 v54, s62, v248
  s_add_u32 s39, s37, s36
L_p2:
  s_mov_b32 s18, s17
  s_waitcnt lgkmcnt(0)
  v_readfirstlane_b32 s55, v55
  s_cmp_lt_u32 s55, s25
  s_cbranch_scc1 L_nsw2
  s_call_b64 s[98:99], L_rot
L_nsw2:
  s_cmp_ge_u32 s55, s38
  s_cbranch_scc1 L_p2x
  s_sub_u32 s60, s55, s37
  s_add_u32 s60, s60, s16
  s_cmp_ge_u32 s60, s24
  s_cselect_b32 s17, s19, 0
  s_sub_u32 s60, s60, s17
  s_mov_b32 s17, s60
  s_sub_u32 s58, s60, s36
  s_cmp_lt_u32 s60, s36
  s_cselect_b32 s60, s60, s58
  s_cselect_b32 s68, 0, s57
  s_cselect_b64 s[40:41], s[28:29], s[32:33]
  s_cselect_b64 s[42:43], s[30:31], s[34:35]
  s_lshr_b32 s58, s60, 2
  s_max_u32 s59, s58, 11
  s_sub_u32 s59, s59, 11
  s_mul_i32 s59, s59, s68
  s_mul_i32 s58, s58, s40
  s_sub_u32 s58, s58, s59
  s_and_b32 s59, s60, 3
  s_add_u32 s58, s58, s59
  s_add_u32 s58, s58, s42
  s_sub_u32 s59, s58, s41
  s_cselect_b32 s58, s58, s59
  s_mul_i32 s58, s58, 6144
  s_add_u32 s54, s43, s58
  s_add_u32 s68, s54, 3072
L_p2b:
  s_lshl_b32 s58, s18, 6
  v_add_u32 v5, s58, v13
  ds_read_b64 v[6:7], v5
  s_mov_b64 exec, 1
  ds_add_rtn_u32 v55, v14, v15 offset:10304
  s_mov_b64 exec, -1
  s_waitcnt lgkmcnt(1)
  s_waitcnt vmcnt(3)
  v_fma_f32 v3, v6, s62, -v54
  v_exp_f32 v3, v3
  s_nop 0
  v_cvt_pk_bf16_f32 v4, v3, 0
  v_add_f32 v52, v52, v3
  v_lshlrev_b32 v5, 16, v4
  v_dot2c_f32_bf16 v28, v56, v4
  v_dot2c_f32_bf16 v29, v56, v5
  v_dot2c_f32_bf16 v30, v57, v4
  v_dot2c_f32_bf16 v31, v57, v5
  v_dot2c_f32_bf16 v32, v58, v4
  v_dot2c_f32_bf16 v33, v58, v5
  v_dot2c_f32_bf16 v34, v59, v4
  v_dot2c_f32_bf16 v35, v59, v5
  v_dot2c_f32_bf16 v36, v60, v4
  v_dot2c_f32_bf16 v37, v60, v5
  v_dot2c_f32_bf16 v38, v61, v4
  v_dot2c_f32_bf16 v39, v61, v5
  v_dot2c_f32_bf16 v40, v62, v4
  v_dot2c_f32_bf16 v41, v62, v5
  v_dot2c_f32_bf16 v42, v63, v4
  v_dot2c_f32_bf16 v43, v63, v5
  v_dot2c_f32_bf16 v44, v64, v4
  v_dot2c_f32_bf16 v45, v64, v5
  v_dot2c_f32_bf16 v46, v65, v4
  v_dot2c_f32_bf16 v47, v65, v5
  v_dot2c_f32_bf16 v48, v66, v4
  v_dot2c_f32_bf16 v49, v66, v5
  v_dot2c_f32_bf16 v50, v67, v4
  v_dot2c_f32_bf16 v51, v67, v5
  buffer_load_dwordx4 v[56:59], v1, s[8:11], s54 offen offset:0 nt
  buffer_load_dwordx4 v[60:63], v1, s[8:11], s54 offen offset:128 nt
  buffer_load_dwordx4 v[64:67], v1, s[8:11], s54 offen offset:256 nt
  s_waitcnt vmcnt(3)
  v_fma_f32 v3, v7, s62, -v54
  v_exp_f32 v3, v3
  s_nop 0
  v_cvt_pk_bf16_f32 v4, v3, 0
  v_add_f32 v52, v52, v3
  v_lshlrev_b32 v5, 16, v4
  v_dot2c_f32_bf16 v28, v68, v4
  v_dot2c_f32_bf16 v29, v68, v5
  v_dot2c_f32_bf16 v30, v69, v4
  v_dot2c_f32_bf16 v31, v69, v5
  v_dot2c_f32_bf16 v32, v70, v4
  v_dot2c_f32_bf16 v33, v70, v5
  v_dot2c_f32_bf16 v34, v71, v4
  v_dot2c_f32_bf16 v35, v71, v5
  v_dot2c_f32_bf16 v36, v72, v4
  v_dot2c_f32_bf16 v37, v72, v5
  v_dot2c_f32_bf16 v38, v73, v4
  v_dot2c_f32_bf16 v39, v73, v5
  v_dot2c_f32_bf16 v40, v74, v4
  v_dot2c_f32_bf16 v41, v74, v5
  v_dot2c_f32_bf16 v42, v75, v4
  v_dot2c_f32_bf16 v43, v75, v5
  v_dot2c_f32_bf16 v44, v76, v4
  v_dot2c_f32_bf16 v45, v76, v5
  v_dot2c_f32_bf16 v46, v77, v4
  v_dot2c_f32_bf16 v47, v77, v5
  v_dot2c_f32_bf16 v48, v78, v4
  v_dot2c_f32_bf16 v49, v78, v5
  v_dot2c_f32_bf16 v50, v79, v4
  v_dot2c_f32_bf16 v51, v79, v5
  buffer_load_dwordx4 v[68:71], v1, s[12:15], s68 offen offset:0 nt
  buffer_load_dwordx4 v[72:75], v1, s[12:15], s68 offen offset:128 nt
  buffer_load_dwordx4 v[76:79], v1, s[12:15], s68 offen offset:256 nt
  s_mov_b32 s69, s55
L_p2c:
  s_cmp_lt_u32 s55, s39
  s_cbranch_scc1 L_p2
  s_cmp_lg_u32 s39, s38
  s_cbranch_scc1 L_done
L_p3e:
  s_cmp_lg_u32 s70, 0
  s_cbranch_scc1 L_done
  s_branch L_p3
L_p3r:
  buffer_load_dwordx4 v[68:71], v1, s[12:15], s68 offen offset:0 nt
  buffer_load_dwordx4 v[72:75], v1, s[12:15], s68 offen offset:128 nt
  buffer_load_dwordx4 v[76:79], v1, s[12:15], s68 offen offset:256 nt
L_p3:
  s_waitcnt lgkmcnt(0)
  v_readfirstlane_b32 s55, v55
  s_call_b64 s[98:99], L_dyn
  s_mov_b64 exec, 1
  ds_add_rtn_u32 v55, v14, v15 offset:10304
  s_mov_b64 exec, -1
  v_mov_b32 v6, 0
  v_mov_b32 v3, 0
  v_mov_b32 v4, 0
  s_waitcnt vmcnt(3)
  v_dot2c_f32_bf16 v6, v56, v16
  v_dot2c_f32_bf16 v3, v60, v20
  v_dot2c_f32_bf16 v4, v64, v24
  v_dot2c_f32_bf16 v6, v57, v17
  v_dot2c_f32_bf16 v3, v61, v21
  v_dot2c_f32_bf16 v4, v65, v25
  v_dot2c_f32_bf16 v6, v58, v18
  v_dot2c_f32_bf16 v3, v62, v22
  v_dot2c_f32_bf16 v4, v66, v26
  v_dot2c_f32_bf16 v6, v59, v19
  v_dot2c_f32_bf16 v3, v63, v23
  v_dot2c_f32_bf16 v4, v67, v27
  s_nop 1
  v_add_f32 v6, v6, v3
  v_add_f32 v6, v6, v4
  s_nop 1
  v_add_f32_dpp v6, v6, v6 quad_perm:[1,0,3,2] row_mask:0xf bank_mask:0xf
  s_nop 1
  v_add_f32_dpp v6, v6, v6 quad_perm:[2,3,0,1] row_mask:0xf bank_mask:0xf
  s_nop 1
  v_add_f32_dpp v6, v6, v6 row_half_mirror row_mask:0xf bank_mask:0xf
  v_cvt_pk_bf16_f32 v6, v6, v6
  v_lshlrev_b32 v6, 16, v6
  v_mul_f32 v6, s61, v6
  v_cvt_pk_bf16_f32 v6, v6, v6
  v_lshlrev_b32 v6, 16, v6
  buffer_load_dwordx4 v[56:59], v1, s[8:11], s54 offen offset:0 nt
  buffer_load_dwordx4 v[60:63], v1, s[8:11], s54 offen offset:128 nt
  buffer_load_dwordx4 v[64:67], v1, s[8:11], s54 offen offset:256 nt
  v_cmp_gt_f32 vcc, v6, v53
  s_cbranch_vccnz L_rare
L_back:
  s_waitcnt vmcnt(3)
  v_fma_f32 v3, v6, s62, -v54
  v_exp_f32 v3, v3
  s_nop 0
  v_cvt_pk_bf16_f32 v4, v3, 0
  v_add_f32 v52, v52, v3
  v_lshlrev_b32 v5, 16, v4
  v_dot2c_f32_bf16 v28, v68, v4
  v_dot2c_f32_bf16 v29, v68, v5
  v_dot2c_f32_bf16 v30, v69, v4
  v_dot2c_f32_bf16 v31, v69, v5
  v_dot2c_f32_bf16 v32, v70, v4
  v_dot2c_f32_bf16 v33, v70, v5
  v_dot2c_f32_bf16 v34, v71, v4
  v_dot2c_f32_bf16 v35, v71, v5
  v_dot2c_f32_bf16 v36, v72, v4
  v_dot2c_f32_bf16 v37, v72, v5
  v_dot2c_f32_bf16 v38, v73, v4
  v_dot2c_f32_bf16 v39, v73, v5
  v_dot2c_f32_bf16 v40, v74, v4
  v_dot2c_f32_bf16 v41, v74, v5
  v_dot2c_f32_bf16 v42, v75, v4
  v_dot2c_f32_bf16 v43, v75, v5
  v_dot2c_f32_bf16 v44, v76, v4
  v_dot2c_f32_bf16 v45, v76, v5
  v_dot2c_f32_bf16 v46, v77, v4
  v_dot2c_f32_bf16 v47, v77, v5
  v_dot2c_f32_bf16 v48, v78, v4
  v_dot2c_f32_bf16 v49, v78, v5
  v_dot2c_f32_bf16 v50, v79, v4
  v_dot2c_f32_bf16 v51, v79, v5
  s_cmp_eq_u32 s70, 0
  s_cbranch_scc1 L_p3r
L_done:
  v_add_f32_dpp v52, v52, v52 row_ror:8 row_mask:0xf bank_mask:0xf
  v_add_f32_dpp v28, v28, v28 row_ror:8 row_mask:0xf bank_mask:0x3
  v_add_f32_dpp v30, v30, v30 row_ror:8 row_mask:0xf bank_mask:0x3
  v_add_f32_dpp v32, v32, v32 row_ror:8 row_mask:0xf bank_mask:0x3
  v_add_f32_dpp v34, v34, v34 row_ror:8 row_mask:0xf bank_mask:0x3
  v_add_f32_dpp v36, v36, v36 row_ror:8 row_mask:0xf bank_mask:0x3
  v_add_f32_dpp v38, v38, v38 row_ror:8 row_mask:0xf bank_mask:0x3
  v_add_f32_dpp v40, v40, v40 row_ror:8 row_mask:0xf bank_mask:0x3
  v_add_f32_dpp v42, v42, v42 row_ror:8 row_mask:0xf bank_mask:0x3
  v_add_f32_dpp v44, v44, v44 row_ror:8 row_mask:0xf bank_mask:0x3
  v_add_f32_dpp v46, v46, v46 row_ror:8 row_mask:0xf bank_mask:0x3
  v_add_f32_dpp v48, v48, v48 row_ror:8 row_mask:0xf bank_mask:0x3
  v_add_f32_dpp v50, v50, v50 row_ror:8 row_mask:0xf bank_mask:0x3
  v_mov_b32 v5, v52
  v_add_f32_dpp v28, v29, v29 row_ror:8 row_mask:0xf bank_mask:0xc
  v_add_f32_dpp v30, v31, v31 row_ror:8 row_mask:0xf bank_mask:0xc
  v_add_f32_dpp v32, v33, v33 row_ror:8 row_mask:0xf bank_mask:0xc
  v_add_f32_dpp v34, v35, v35 row_ror:8 row_mask:0xf bank_mask:0xc
  v_add_f32_dpp v36, v37, v37 row_ror:8 row_mask:0xf bank_mask:0xc
  v_add_f32_dpp v38, v39, v39 row_ror:8 row_mask:0xf bank_mask:0xc
  v_add_f32_dpp v40, v41, v41 row_ror:8 row_mask:0xf bank_mask:0xc
  v_add_f32_dpp v42, v43, v43 row_ror:8 row_mask:0xf bank_mask:0xc
  v_add_f32_dpp v44, v45, v45 row_ror:8 row_mask:0xf bank_mask:0xc
  v_add_f32_dpp v46, v47, v47 row_ror:8 row_mask:0xf bank_mask:0xc
  v_add_f32_dpp v48, v49, v49 row_ror:8 row_mask:0xf bank_mask:0xc
  v_add_f32_dpp v50, v51, v51 row_ror:8 row_mask:0xf bank_mask:0xc
  v_permlane32_swap_b32 v52, v5
  v_permlane32_swap_b32 v28, v32
  v_permlane32_swap_b32 v30, v34
  v_permlane32_swap_b32 v36, v40
  v_permlane32_swap_b32 v38, v42
  v_permlane32_swap_b32 v44, v48
  v_permlane32_swap_b32 v46, v50
  v_add_f32 v4, v52, v5
  v_add_f32 v52, v52, v5
  v_add_f32 v28, v28, v32
  v_add_f32 v30, v30, v34
  v_add_f32 v36, v36, v40
  v_add_f32 v38, v38, v42
  v_add_f32 v44, v44, v48
  v_add_f32 v46, v46, v50
  v_permlane16_swap_b32 v52, v4
  v_permlane16_swap_b32 v28, v30
  v_permlane16_swap_b32 v36, v38
  v_permlane16_swap_b32 v44, v46
  v_add_f32 v52, v52, v4
  v_add_f32 v28, v28, v30
  v_add_f32 v36, v36, v38
  v_add_f32 v44, v44, v46
  v_mov_b32_dpp v52, v54 quad_perm:[0,1,2,3] row_mask:0xf bank_mask:0x3
  ds_write2_b32 v2, v28, v36 offset0:0 offset1:2
  ds_write2_b32 v2, v44, v52 offset0:128 offset1:130
  s_cmp_lg_u32 s39, s38
  s_cbranch_scc1 L_p2s
  s_waitcnt lgkmcnt(0)
  s_barrier
  s_branch L_tail
L_helper:
  s_load_dwordx2 s[28:29], s[0:1], 32
  s_load_dwordx2 s[32:33], s[0:1], 48
  s_load_dwordx2 s[36:37], s[0:1], 56
  s_load_dwordx2 s[40:41], s[0:1], 64
  v_lshrrev_b32 v3, 3, v0
  v_and_b32 v4, 7, v0
  v_mul_u32_u24 v1, 122880, v3
  v_lshl_add_u32 v1, v4, 4, v1
  v_mul_u32_u24 v3, 20, v3
  v_mul_u32_u24 v5, 20, v0
  s_mul_i32 s57, s52, 12
  s_lshr_b32 s58, s53, 1
  s_add_u32 s57, s57, s58
  s_and_b32 s58, s53, 1
  s_lshl_b32 s58, s58, 2
  s_add_u32 s58, s58, s3
  s_mul_i32 s59, s58, 983040
  s_lshl_b32 s60, s57, 7
  s_add_u32 s59, s59, s60
  s_mul_i32 s60, s58, 160
  s_cmp_ge_u32 s53, 24
  s_cselect_b32 s18, 0, s18
  s_cselect_b32 s26, 0, s26
  s_waitcnt lgkmcnt(0)
  buffer_load_dwordx4 v[28:31], v5, s[24:27], 0 offen
  buffer_load_dword v32, v5, s[24:27], 0 offen offset:16
  buffer_load_dwordx4 v[48:51], v3, s[24:27], s60 offen
  buffer_load_dword v52, v3, s[24:27], s60 offen offset:16
  buffer_load_dwordx4 v[56:59], v1, s[16:19], s59 offen nt
  s_add_u32 s59, s59, 12288
  buffer_load_dwordx4 v[60:63], v1, s[16:19], s59 offen nt
  s_add_u32 s59, s59, 12288
  buffer_load_dwordx4 v[64:67], v1, s[16:19], s59 offen nt
  s_add_u32 s59, s59, 12288
  buffer_load_dwordx4 v[68:71], v1, s[16:19], s59 offen nt
  s_add_u32 s59, s59, 12288
  buffer_load_dwordx4 v[72:75], v1, s[16:19], s59 offen nt
  s_add_u32 s59, s59, 12288
  buffer_load_dwordx4 v[76:79], v1, s[16:19], s59 offen nt
  s_add_u32 s59, s59, 12288
  buffer_load_dwordx4 v[80:83], v1, s[16:19], s59 offen nt
  s_add_u32 s59, s59, 12288
  buffer_load_dwordx4 v[84:87], v1, s[16:19], s59 offen nt
  s_add_u32 s59, s59, 12288
  buffer_load_dwordx4 v[88:91], v1, s[16:19], s59 offen nt
  s_add_u32 s59, s59, 12288
  buffer_load_dwordx4 v[92:95], v1, s[16:19], s59 offen nt
  s_lshl_b32 s58, s52, 5
  s_add_u32 s58, s58, s53
  s_sub_u32 s58, s58, 32
  s_cmp_lt_u32 s58, 160
  s_cselect_b32 s5, 0, 3
  s_cselect_b32 s58, s58, 0
  s_cmp_eq_u32 s52, 0
  s_cselect_b32 s5, 1, s5
  s_mul_i32 s100, s58, 205
  s_lshr_b32 s100, s100, 11
  s_mul_i32 s4, s100, 10
  s_sub_u32 s4, s58, s4
  s_and_b32 s58, s100, 1
  s_lshl_b32 s58, s58, 3
  s_lshr_b32 s100, s100, 1
  s_add_u32 s100, s100, s58
  s_cmp_eq_u32 s5, 0
  s_cselect_b32 s30, 7864320, 0
  s_mov_b32 s31, 0x20000
  v_lshrrev_b32 v9, 3, v0
  v_mul_u32_u24 v9, 2560, v9
  v_lshl_add_u32 v9, v4, 4, v9
  s_mov_b32 s7, s3
  s_lshr_b32 s6, s7, 2
  s_lshl_b32 s6, s6, 3
  s_add_u32 s6, s6, s100
  s_cmp_lt_u32 s100, 8
  s_cselect_b32 s58, 16, -8
  s_add_u32 s6, s6, s58
  s_mul_i32 s58, s6, 245760
  s_mul_i32 s59, s3, 20480
  s_add_u32 s58, s58, s59
  s_lshl_b32 s59, s4, 7
  s_add_u32 s58, s58, s59
  buffer_load_dwordx4 v[96:99], v9, s[28:31], s58 offen offset:0
  buffer_load_dwordx4 v[100:103], v9, s[28:31], s58 offen offset:1280
  s_add_u32 s58, s58, 81920
  buffer_load_dwordx4 v[104:107], v9, s[28:31], s58 offen offset:0
  buffer_load_dwordx4 v[108:111], v9, s[28:31], s58 offen offset:1280
  s_add_u32 s58, s58, 81920
  buffer_load_dwordx4 v[112:115], v9, s[28:31], s58 offen offset:0
  buffer_load_dwordx4 v[116:119], v9, s[28:31], s58 offen offset:1280
  s_add_u32 s58, s58, 1802240
  buffer_load_dwordx4 v[120:123], v9, s[28:31], s58 offen offset:0
  buffer_load_dwordx4 v[124:127], v9, s[28:31], s58 offen offset:1280
  s_add_u32 s58, s58, 81920
  buffer_load_dwordx4 v[128:131], v9, s[28:31], s58 offen offset:0
  buffer_load_dwordx4 v[132:135], v9, s[28:31], s58 offen offset:1280
  s_add_u32 s58, s58, 81920
  buffer_load_dwordx4 v[136:139], v9, s[28:31], s58 offen offset:0
  buffer_load_dwordx4 v[140:143], v9, s[28:31], s58 offen offset:1280
  s_add_u32 s58, s58, 1802240
  s_mov_b32 s26, 1280
  v_mov_b32 v8, -1
  v_mov_b32 v9, -1
  v_mov_b32 v10, -1
  v_mov_b32 v11, -1
  s_lshl_b32 s58, s3, 10
  v_lshl_add_u32 v7, v0, 4, s58
  ds_write_b128 v7, v[8:11] offset:11264
  v_mov_b32 v12, 48
  v_mov_b32 v13, 0
  v_mov_b32 v14, 0
  v_mov_b32 v15, 0
  ds_write_b128 v13, v[12:15] offset:10304
  ds_write_b64 v13, v[14:15] offset:10320
  s_waitcnt lgkmcnt(0)
  s_barrier
  s_mov_b32 s22, 1010432
  s_mov_b32 s23, 0x20000
  s_mov_b32 s46, 1280
  s_mov_b32 s47, 0x20000
  s_mov_b32 s30, 7864320
  s_mov_b32 s31, 0x20000
  s_mov_b32 s34, 1966080
  s_mov_b32 s35, 0x20000
  s_mov_b32 s38, 1966080
  s_mov_b32 s39, 0x20000
  s_mov_b32 s42, 1966080
  s_mov_b32 s43, 0x20000
  s_mov_b32 s61, 0x3d93cd3a
  s_mov_b32 s62, 0x3fb8aa3b
  s_mov_b32 s63, 0xffff0000
  s_mov_b32 s7, s3
  s_mov_b32 s71, 0
  s_mov_b32 s74, 0x05040100
  s_mov_b32 s75, 0x07060302
  s_mov_b32 s101, 0x100000
  s_load_dwordx2 s[72:73], s[20:21], 172032
  s_lshl_b32 s58, s52, 5
  s_add_u32 s58, s58, s53
  s_mul_i32 s50, s58, 5462
  s_lshr_b32 s50, s50, 16
  s_mul_i32 s64, s50, 12
  s_sub_u32 s64, s58, s64
  s_lshl_b32 s58, s52, 5
  s_add_u32 s58, s58, s53
  s_sub_u32 s58, s58, 32
  s_cmp_lt_u32 s58, 160
  s_cselect_b32 s5, 0, 3
  s_cselect_b32 s58, s58, 0
  s_cmp_eq_u32 s52, 0
  s_cselect_b32 s5, 1, s5
  s_mul_i32 s100, s58, 205
  s_lshr_b32 s100, s100, 11
  s_mul_i32 s4, s100, 10
  s_sub_u32 s4, s58, s4
  s_and_b32 s58, s100, 1
  s_lshl_b32 s58, s58, 3
  s_lshr_b32 s100, s100, 1
  s_add_u32 s100, s100, s58
  s_cmp_lt_u32 s64, 8
  s_cselect_b32 s55, 43, 42
  s_cmp_eq_u32 s52, 0
  s_cselect_b32 s56, 11, 18
  s_add_u32 s56, s56, s55
  s_lshl_b32 s56, s56, 2
  s_lshl_b32 s55, s55, 2
  s_lshl_b32 s56, s56, 1
  s_sub_u32 s56, s56, 3
  s_cmp_eq_u32 s50, 21
  s_cselect_b32 s58, 16, 0
  s_add_u32 s64, s64, s58
  s_mul_i32 s58, s52, 14
  s_mul_i32 s51, s53, 9
  s_add_u32 s58, s58, s51
  s_add_u32 s58, s58, 8
  s_and_b32 s58, s58, 31
  s_add_u32 s58, s58, 1
  s_mul_i32 s51, s58, 43
  s_lshr_b32 s51, s51, 7
  s_mul_i32 s65, s51, 3
  s_sub_u32 s65, s58, s65
  s_cmp_eq_u32 s51, 0
  s_cselect_b32 s66, 2, 3
  s_cselect_b32 s58, 1, 0
  s_sub_u32 s65, s65, s58
  s_add_u32 s58, s52, 7
  s_and_b32 s58, s58, 7
  s_mul_i32 s58, s66, s58
  s_add_u32 s65, s65, s58
  s_lshl_b32 s66, s66, 3
  s_cmp_ge_u32 s53, 24
  s_cbranch_scc1 L_noq
  v_lshlrev_b32 v2, 5, v4
  v_lshrrev_b32 v3, 4, v0
  v_lshl_add_u32 v2, v3, 3, v2
  s_lshl_b32 s58, s3, 8
  v_add_u32 v2, s58, v2
  s_waitcnt vmcnt(24)
  v_lshlrev_b32 v36, 16, v28
  v_and_b32 v37, s63, v28
  v_lshlrev_b32 v38, 16, v29
  v_and_b32 v39, s63, v29
  v_lshlrev_b32 v40, 16, v30
  v_and_b32 v41, s63, v30
  v_lshlrev_b32 v42, 16, v31
  v_and_b32 v43, s63, v31
  v_lshlrev_b32 v44, 16, v32
  v_and_b32 v45, s63, v32
  v_add_f32 v5, v36, v37
  v_add_f32 v5, v5, v38
  v_add_f32 v5, v5, v39
  v_add_f32 v5, v5, v40
  v_add_f32 v5, v5, v41
  v_add_f32 v5, v5, v42
  v_add_f32 v5, v5, v43
  v_add_f32 v5, v5, v44
  v_add_f32 v5, v5, v45
  s_nop 1
  v_add_f32_dpp v5, v5, v5 quad_perm:[1,0,3,2] row_mask:0xf bank_mask:0xf
  s_nop 1
  v_add_f32_dpp v5, v5, v5 quad_perm:[2,3,0,1] row_mask:0xf bank_mask:0xf
  s_nop 1
  v_add_f32_dpp v5, v5, v5 row_half_mirror row_mask:0xf bank_mask:0xf
  s_nop 1
  v_add_f32_dpp v5, v5, v5 row_ror:8 row_mask:0xf bank_mask:0xf
  v_mov_b32 v6, v5
  s_nop 1
  v_permlane16_swap_b32 v5, v6
  v_add_f32 v5, v5, v6
  v_mov_b32 v6, v5
  s_nop 1
  v_permlane32_swap_b32 v5, v6
  v_add_f32 v5, v5, v6
  v_mul_f32 v7, 0x3acccccd, v5
  v_sub_f32 v36, v36, v7
  v_sub_f32 v37, v37, v7
  v_sub_f32 v38, v38, v7
  v_sub_f32 v39, v39, v7
  v_sub_f32 v40, v40, v7
  v_sub_f32 v41, v41, v7
  v_sub_f32 v42, v42, v7
  v_sub_f32 v43, v43, v7
  v_sub_f32 v44, v44, v7
  v_sub_f32 v45, v45, v7
  v_mul_f32 v5, v36, v36
  v_fmac_f32 v5, v37, v37
  v_fmac_f32 v5, v38, v38
  v_fmac_f32 v5, v39, v39
  v_fmac_f32 v5, v40, v40
  v_fmac_f32 v5, v41, v41
  v_fmac_f32 v5, v42, v42
  v_fmac_f32 v5, v43, v43
  v_fmac_f32 v5, v44, v44
  v_fmac_f32 v5, v45, v45
  s_nop 1
  v_add_f32_dpp v5, v5, v5 quad_perm:[1,0,3,2] row_mask:0xf bank_mask:0xf
  s_nop 1
  v_add_f32_dpp v5, v5, v5 quad_perm:[2,3,0,1] row_mask:0xf bank_mask:0xf
  s_nop 1
  v_add_f32_dpp v5, v5, v5 row_half_mirror row_mask:0xf bank_mask:0xf
  s_nop 1
  v_add_f32_dpp v5, v5, v5 row_ror:8 row_mask:0xf bank_mask:0xf
  v_mov_b32 v6, v5
  s_nop 1
  v_permlane16_swap_b32 v5, v6
  v_add_f32 v5, v5, v6
  v_mov_b32 v6, v5
  s_nop 1
  v_permlane32_swap_b32 v5, v6
  v_add_f32 v5, v5, v6
  v_mul_f32 v5, 0x3acccccd, v5
  v_cvt_pk_bf16_f32 v6, v5, v7
  v_lshlrev_b32 v5, 16, v6
  v_and_b32 v7, s63, v6
  v_add_f32 v5, 0x3727c5ac, v5
  v_cvt_pk_bf16_f32 v5, v5, v5
  v_lshlrev_b32 v5, 16, v5
  v_sqrt_f32 v8, v5
  s_waitcnt vmcnt(22)
  v_lshlrev_b32 v16, 16, v48
  v_and_b32 v17, s63, v48
  v_lshlrev_b32 v18, 16, v49
  v_and_b32 v19, s63, v49
  v_lshlrev_b32 v20, 16, v50
  v_and_b32 v21, s63, v50
  v_lshlrev_b32 v22, 16, v51
  v_and_b32 v23, s63, v51
  v_lshlrev_b32 v24, 16, v52
  v_and_b32 v25, s63, v52
  v_cvt_pk_bf16_f32 v8, v8, v8
  v_lshlrev_b32 v8, 16, v8
  v_rcp_f32 v9, v8
  v_sub_f32 v16, v16, v7
  v_sub_f32 v17, v17, v7
  v_sub_f32 v18, v18, v7
  v_sub_f32 v19, v19, v7
  v_sub_f32 v20, v20, v7
  v_sub_f32 v21, v21, v7
  v_sub_f32 v22, v22, v7
  v_sub_f32 v23, v23, v7
  v_sub_f32 v24, v24, v7
  v_sub_f32 v25, v25, v7
  v_cvt_pk_bf16_f32 v6, v16, v17
  v_lshlrev_b32 v16, 16, v6
  v_and_b32 v17, s63, v6
  v_cvt_pk_bf16_f32 v6, v18, v19
  v_lshlrev_b32 v18, 16, v6
  v_and_b32 v19, s63, v6
  v_cvt_pk_bf16_f32 v6, v20, v21
  v_lshlrev_b32 v20, 16, v6
  v_and_b32 v21, s63, v6
  v_cvt_pk_bf16_f32 v6, v22, v23
  v_lshlrev_b32 v22, 16, v6
  v_and_b32 v23, s63, v6
  v_cvt_pk_bf16_f32 v6, v24, v25
  v_lshlrev_b32 v24, 16, v6
  v_and_b32 v25, s63, v6
  v_mul_f32 v36, v16, v9
  v_mul_f32 v37, v17, v9
  v_mul_f32 v38, v18, v9
  v_mul_f32 v39, v19, v9
  v_mul_f32 v40, v20, v9
  v_mul_f32 v41, v21, v9
  v_mul_f32 v42, v22, v9
  v_mul_f32 v43, v23, v9
  v_mul_f32 v44, v24, v9
  v_mul_f32 v45, v25, v9
  v_fma_f32 v16, -v36, v8, v16
  v_fma_f32 v17, -v37, v8, v17
  v_fma_f32 v18, -v38, v8, v18
  v_fma_f32 v19, -v39, v8, v19
  v_fma_f32 v20, -v40, v8, v20
  v_fma_f32 v21, -v41, v8, v21
  v_fma_f32 v22, -v42, v8, v22
  v_fma_f32 v23, -v43, v8, v23
  v_fma_f32 v24, -v44, v8, v24
  v_fma_f32 v25, -v45, v8, v25
  v_fmac_f32 v36, v16, v9
  v_fmac_f32 v37, v17, v9
  v_fmac_f32 v38, v18, v9
  v_fmac_f32 v39, v19, v9
  v_fmac_f32 v40, v20, v9
  v_fmac_f32 v41, v21, v9
  v_fmac_f32 v42, v22, v9
  v_fmac_f32 v43, v23, v9
  v_fmac_f32 v44, v24, v9
  v_fmac_f32 v45, v25, v9
  v_cvt_pk_bf16_f32 v16, v36, 0
  v_cvt_pk_bf16_f32 v17, v37, 0
  v_cvt_pk_bf16_f32 v18, v38, 0
  v_cvt_pk_bf16_f32 v19, v39, 0
  v_cvt_pk_bf16_f32 v20, v40, 0
  v_cvt_pk_bf16_f32 v21, v41, 0
  v_cvt_pk_bf16_f32 v22, v42, 0
  v_cvt_pk_bf16_f32 v23, v43, 0
  v_cvt_pk_bf16_f32 v24, v44, 0
  v_cvt_pk_bf16_f32 v25, v45, 0
  v_lshlrev_b32 v36, 16, v16
  v_lshlrev_b32 v37, 16, v17
  v_lshlrev_b32 v38, 16, v18
  v_lshlrev_b32 v39, 16, v19
  v_lshlrev_b32 v40, 16, v20
  v_lshlrev_b32 v41, 16, v21
  v_lshlrev_b32 v42, 16, v22
  v_lshlrev_b32 v43, 16, v23
  v_lshlrev_b32 v44, 16, v24
  v_lshlrev_b32 v45, 16, v25
  v_mov_b32 v28, 0
  v_mov_b32 v29, 0
  v_mov_b32 v30, 0
  v_mov_b32 v31, 0
  v_mov_b32 v32, 0
  v_mov_b32 v33, 0
  v_mov_b32 v34, 0
  v_mov_b32 v35, 0
  s_waitcnt vmcnt(21)
  v_dot2c_f32_bf16 v28, v56, v16
  v_dot2c_f32_bf16 v29, v56, v36
  v_dot2c_f32_bf16 v30, v57, v16
  v_dot2c_f32_bf16 v31, v57, v36
  v_dot2c_f32_bf16 v32, v58, v16
  v_dot2c_f32_bf16 v33, v58, v36
  v_dot2c_f32_bf16 v34, v59, v16
  v_dot2c_f32_bf16 v35, v59, v36
  s_waitcnt vmcnt(20)
  v_dot2c_f32_bf16 v28, v60, v17
  v_dot2c_f32_bf16 v29, v60, v37
  v_dot2c_f32_bf16 v30, v61, v17
  v_dot2c_f32_bf16 v31, v61, v37
  v_dot2c_f32_bf16 v32, v62, v17
  v_dot2c_f32_bf16 v33, v62, v37
  v_dot2c_f32_bf16 v34, v63, v17
  v_dot2c_f32_bf16 v35, v63, v37
  s_waitcnt vmcnt(19)
  v_dot2c_f32_bf16 v28, v64, v18
  v_dot2c_f32_bf16 v29, v64, v38
  v_dot2c_f32_bf16 v30, v65, v18
  v_dot2c_f32_bf16 v31, v65, v38
  v_dot2c_f32_bf16 v32, v66, v18
  v_dot2c_f32_bf16 v33, v66, v38
  v_dot2c_f32_bf16 v34, v67, v18
  v_dot2c_f32_bf16 v35, v67, v38
  s_waitcnt vmcnt(18)
  v_dot2c_f32_bf16 v28, v68, v19
  v_dot2c_f32_bf16 v29, v68, v39
  v_dot2c_f32_bf16 v30, v69, v19
  v_dot2c_f32_bf16 v31, v69, v39
  v_dot2c_f32_bf16 v32, v70, v19
  v_dot2c_f32_bf16 v33, v70, v39
  v_dot2c_f32_bf16 v34, v71, v19
  v_dot2c_f32_bf16 v35, v71, v39
  s_waitcnt vmcnt(17)
  v_dot2c_f32_bf16 v28, v72, v20
  v_dot2c_f32_bf16 v29, v72, v40
  v_dot2c_f32_bf16 v30, v73, v20
  v_dot2c_f32_bf16 v31, v73, v40
  v_dot2c_f32_bf16 v32, v74, v20
  v_dot2c_f32_bf16 v33, v74, v40
  v_dot2c_f32_bf16 v34, v75, v20
  v_dot2c_f32_bf16 v35, v75, v40
  s_waitcnt vmcnt(16)
  v_dot2c_f32_bf16 v28, v76, v21
  v_dot2c_f32_bf16 v29, v76, v41
  v_dot2c_f32_bf16 v30, v77, v21
  v_dot2c_f32_bf16 v31, v77, v41
  v_dot2c_f32_bf16 v32, v78, v21
  v_dot2c_f32_bf16 v33, v78, v41
  v_dot2c_f32_bf16 v34, v79, v21
  v_dot2c_f32_bf16 v35, v79, v41
  s_waitcnt vmcnt(15)
  v_dot2c_f32_bf16 v28, v80, v22
  v_dot2c_f32_bf16 v29, v80, v42
  v_dot2c_f32_bf16 v30, v81, v22
  v_dot2c_f32_bf16 v31, v81, v42
  v_dot2c_f32_bf16 v32, v82, v22
  v_dot2c_f32_bf16 v33, v82, v42
  v_dot2c_f32_bf16 v34, v83, v22
  v_dot2c_f32_bf16 v35, v83, v42
  s_waitcnt vmcnt(14)
  v_dot2c_f32_bf16 v28, v84, v23
  v_dot2c_f32_bf16 v29, v84, v43
  v_dot2c_f32_bf16 v30, v85, v23
  v_dot2c_f32_bf16 v31, v85, v43
  v_dot2c_f32_bf16 v32, v86, v23
  v_dot2c_f32_bf16 v33, v86, v43
  v_dot2c_f32_bf16 v34, v87, v23
  v_dot2c_f32_bf16 v35, v87, v43
  s_waitcnt vmcnt(13)
  v_dot2c_f32_bf16 v28, v88, v24
  v_dot2c_f32_bf16 v29, v88, v44
  v_dot2c_f32_bf16 v30, v89, v24
  v_dot2c_f32_bf16 v31, v89, v44
  v_dot2c_f32_bf16 v32, v90, v24
  v_dot2c_f32_bf16 v33, v90, v44
  v_dot2c_f32_bf16 v34, v91, v24
  v_dot2c_f32_bf16 v35, v91, v44
  s_waitcnt vmcnt(12)
  v_dot2c_f32_bf16 v28, v92, v25
  v_dot2c_f32_bf16 v29, v92, v45
  v_dot2c_f32_bf16 v30, v93, v25
  v_dot2c_f32_bf16 v31, v93, v45
  v_dot2c_f32_bf16 v32, v94, v25
  v_dot2c_f32_bf16 v33, v94, v45
  v_dot2c_f32_bf16 v34, v95, v25
  v_dot2c_f32_bf16 v35, v95, v45
  v_permlane32_swap_b32 v28, v32
  v_permlane32_swap_b32 v29, v33
  v_permlane32_swap_b32 v30, v34
  v_permlane32_swap_b32 v31, v35
  v_add_f32 v28, v28, v32
  v_add_f32 v29, v29, v33
  v_add_f32 v30, v30, v34
  v_add_f32 v31, v31, v35
  s_nop 0
  v_permlane16_swap_b32 v28, v30
  v_permlane16_swap_b32 v29, v31
  v_add_f32 v28, v28, v30
  v_add_f32 v29, v29, v31
  s_nop 0
  v_add_f32_dpp v28, v28, v28 row_ror:8 row_mask:0xf bank_mask:0xf
  v_add_f32_dpp v29, v29, v29 row_ror:8 row_mask:0xf bank_mask:0xf
  ds_write_b64 v2, v[28:29] offset:9216
  v_mov_b32 v4, 1
  s_mov_b64 exec, 1
  ds_add_rtn_u32 v3, v13, v4 offset:10316
  s_mov_b64 exec, -1
  v_lshlrev_b32 v1, 4, v0
  s_waitcnt lgkmcnt(0)
  s_add_u32 s72, s72, 1
  s_mul_i32 s73, s73, 0x9e3779b1
  s_add_u32 s73, s73, 0x7f4a7c15
  v_readfirstlane_b32 s58, v3
  s_cmp_lg_u32 s58, 3
  s_cbranch_scc1 L_hq
  s_mov_b32 exec_hi, 0
  v_lshlrev_b32 v3, 3, v0
  ds_read_b64 v[28:29], v3 offset:9216
  ds_read_b64 v[30:31], v3 offset:9472
  ds_read_b64 v[32:33], v3 offset:9728
  ds_read_b64 v[34:35], v3 offset:9984
  s_lshl_b32 s58, s57, 9
  s_and_b32 s59, s53, 1
  s_mul_i32 s59, s59, 49152
  s_add_u32 s58, s58, s59
  s_add_u32 s58, s58, 73728
  v_mov_b32 v9, s72
  v_mov_b32 v11, s73
  s_waitcnt lgkmcnt(0)
  v_add_f32 v28, v28, v30
  v_add_f32 v29, v29, v31
  v_add_f32 v32, v32, v34
  v_add_f32 v33, v33, v35
  v_add_f32 v8, v28, v32
  v_add_f32 v10, v29, v33
  buffer_store_dwordx4 v[8:11], v1, s[20:23], s58 offen sc1
  s_branch L_hg
L_noq:
  v_lshlrev_b32 v1, 4, v0
  s_waitcnt lgkmcnt(0)
  s_add_u32 s72, s72, 1
  s_mul_i32 s73, s73, 0x9e3779b1
  s_add_u32 s73, s73, 0x7f4a7c15
  s_cmp_lg_u32 s3, 0
  s_cbranch_scc1 L_hq
L_hg:
  s_mul_i32 s59, s50, 1536
  s_add_u32 s59, s59, 73728
  s_mul_i32 s60, s51, 1536
  s_add_u32 s60, s60, 105984
  s_mov_b32 exec_lo, -1
  s_mov_b32 exec_hi, 0xffff
  v_add_u32 v4, 49152, v1
L_poll1:
  buffer_load_dwordx4 v[56:59], v1, s[20:23], s59 offen offset:0 sc1
  buffer_load_dwordx4 v[60:63], v1, s[20:23], s59 offen offset:768 sc1
  buffer_load_dwordx4 v[64:67], v4, s[20:23], s59 offen offset:0 sc1
  buffer_load_dwordx4 v[68:71], v4, s[20:23], s59 offen offset:768 sc1
  buffer_load_dwordx4 v[72:75], v1, s[20:23], s60 offen offset:0 sc1
  buffer_load_dwordx4 v[76:79], v1, s[20:23], s60 offen offset:768 sc1
  buffer_load_dwordx4 v[80:83], v4, s[20:23], s60 offen offset:0 sc1
  buffer_load_dwordx4 v[84:87], v4, s[20:23], s60 offen offset:768 sc1
  s_waitcnt vmcnt(0)
  v_xor_b32 v3, s72, v57
  v_bitop3_b32 v3, v3, v59, s73 bitop3:0xf6
  v_bitop3_b32 v3, v3, v61, s72 bitop3:0xf6
  v_bitop3_b32 v3, v3, v63, s73 bitop3:0xf6
  v_bitop3_b32 v3, v3, v65, s72 bitop3:0xf6
  v_bitop3_b32 v3, v3, v67, s73 bitop3:0xf6
  v_bitop3_b32 v3, v3, v69, s72 bitop3:0xf6
  v_bitop3_b32 v3, v3, v71, s73 bitop3:0xf6
  v_bitop3_b32 v3, v3, v73, s72 bitop3:0xf6
  v_bitop3_b32 v3, v3, v75, s73 bitop3:0xf6
  v_bitop3_b32 v3, v3, v77, s72 bitop3:0xf6
  v_bitop3_b32 v3, v3, v79, s73 bitop3:0xf6
  v_bitop3_b32 v3, v3, v81, s72 bitop3:0xf6
  v_bitop3_b32 v3, v3, v83, s73 bitop3:0xf6
  v_bitop3_b32 v3, v3, v85, s72 bitop3:0xf6
  v_bitop3_b32 v3, v3, v87, s73 bitop3:0xf6
  v_cmp_ne_u32 vcc, 0, v3
  s_cbranch_vccz L_poll1_done
  s_mov_b64 exec, vcc
  s_sleep 4
  s_sub_u32 s101, s101, 1
  s_cbranch_scc0 L_poll1
L_poll1_done:
  s_mov_b64 exec, -1
  v_lshlrev_b32 v3, 2, v0
  s_mov_b32 exec_lo, -1
  s_mov_b32 exec_hi, 0xffff
  v_add_f32 v56, v56, v64
  v_add_f32 v58, v58, v66
  v_cvt_pk_bf16_f32 v56, v56, v58
  ds_write_b32 v3, v56 offset:8192
  v_add_f32 v60, v60, v68
  v_add_f32 v62, v62, v70
  v_cvt_pk_bf16_f32 v60, v60, v62
  ds_write_b32 v3, v60 offset:8384
  v_add_f32 v72, v72, v80
  v_add_f32 v74, v74, v82
  v_cvt_pk_bf16_f32 v72, v72, v74
  ds_write_b32 v3, v72 offset:8704
  v_add_f32 v76, v76, v84
  v_add_f32 v78, v78, v86
  v_cvt_pk_bf16_f32 v76, v76, v78
  ds_write_b32 v3, v76 offset:8896
  s_mov_b64 exec, -1
L_hq:
  s_waitcnt lgkmcnt(0)
  s_barrier
  s_cmp_lg_u32 s3, 1
  s_cbranch_scc1 L_noclr
  s_cmp_ge_u32 s2, 40
  s_cbranch_scc1 L_noclr
  v_mov_b32 v8, -1
  v_mov_b32 v9, -1
  v_mov_b32 v10, -1
  v_mov_b32 v11, -1
  s_lshl_b32 s58, s2, 10
  buffer_store_dwordx4 v[8:11], v1, s[20:23], s58 offen sc1
  s_mul_i32 s58, s2, 4352
  s_add_u32 s58, s58, 962560
  s_mov_b64 exec, 15
  buffer_store_dwordx4 v[8:11], v1, s[20:23], s58 offen sc1
  s_mov_b64 exec, -1
  s_mov_b32 s67, 1
  s_waitcnt vmcnt(0)
  s_atomic_add s67, s[48:49], 0
L_noclr:
  s_cmp_eq_u32 s5, 3
  s_cbranch_scc1 L_now
  s_add_u32 s55, s55, 0
  s_cmp_eq_u32 s5, 1
  s_cselect_b32 s55, s55, 350
  v_mov_b32 v3, 0
L_lw1:
  s_sleep 8
  ds_read_b32 v4, v3 offset:10304
  s_waitcnt lgkmcnt(0)
  v_readfirstlane_b32 s58, v4
  s_cmp_lt_u32 s58, s55
  s_cbranch_scc1 L_lw1
  s_cmp_eq_u32 s5, 1
  s_cbranch_scc1 L_wf
  v_lshrrev_b32 v9, 3, v0
  v_and_b32 v10, 7, v0
  v_lshl_add_u32 v12, v10, 3, v9
  s_mul_i32 s58, s3, 6144
  v_lshl_add_u32 v12, v12, 4, s58
  s_waitcnt vmcnt(0)
  v_perm_b32 v224, v100, v96, s74
  v_perm_b32 v225, v100, v96, s75
  v_perm_b32 v226, v101, v97, s74
  v_perm_b32 v227, v101, v97, s75
  v_perm_b32 v228, v102, v98, s74
  v_perm_b32 v229, v102, v98, s75
  v_perm_b32 v230, v103, v99, s74
  v_perm_b32 v231, v103, v99, s75
  v_perm_b32 v232, v108, v104, s74
  v_perm_b32 v233, v108, v104, s75
  v_perm_b32 v234, v109, v105, s74
  v_perm_b32 v235, v109, v105, s75
  v_perm_b32 v236, v110, v106, s74
  v_perm_b32 v237, v110, v106, s75
  v_perm_b32 v238, v111, v107, s74
  v_perm_b32 v239, v111, v107, s75
  v_perm_b32 v240, v116, v112, s74
  v_perm_b32 v241, v116, v112, s75
  v_perm_b32 v242, v117, v113, s74
  v_perm_b32 v243, v117, v113, s75
  v_perm_b32 v244, v118, v114, s74
  v_perm_b32 v245, v118, v114, s75
  v_perm_b32 v246, v119, v115, s74
  v_perm_b32 v247, v119, v115, s75
  ds_write_b128 v12, v[224:227] offset:21504
  ds_write_b128 v12, v[228:231] offset:22528
  ds_write_b128 v12, v[232:235] offset:23552
  ds_write_b128 v12, v[236:239] offset:24576
  ds_write_b128 v12, v[240:243] offset:25600
  ds_write_b128 v12, v[244:247] offset:26624
  s_waitcnt lgkmcnt(0)
  v_perm_b32 v224, v124, v120, s74
  v_perm_b32 v225, v124, v120, s75
  v_perm_b32 v226, v125, v121, s74
  v_perm_b32 v227, v125, v121, s75
  v_perm_b32 v228, v126, v122, s74
  v_perm_b32 v229, v126, v122, s75
  v_perm_b32 v230, v127, v123, s74
  v_perm_b32 v231, v127, v123, s75
  v_perm_b32 v232, v132, v128, s74
  v_perm_b32 v233, v132, v128, s75
  v_perm_b32 v234, v133, v129, s74
  v_perm_b32 v235, v133, v129, s75
  v_perm_b32 v236, v134, v130, s74
  v_perm_b32 v237, v134, v130, s75
  v_perm_b32 v238, v135, v131, s74
  v_perm_b32 v239, v135, v131, s75
  v_perm_b32 v240, v140, v136, s74
  v_perm_b32 v241, v140, v136, s75
  v_perm_b32 v242, v141, v137, s74
  v_perm_b32 v243, v141, v137, s75
  v_perm_b32 v244, v142, v138, s74
  v_perm_b32 v245, v142, v138, s75
  v_perm_b32 v246, v143, v139, s74
  v_perm_b32 v247, v143, v139, s75
  ds_write_b128 v12, v[224:227] offset:46080
  ds_write_b128 v12, v[228:231] offset:47104
  ds_write_b128 v12, v[232:235] offset:48128
  ds_write_b128 v12, v[236:239] offset:49152
  ds_write_b128 v12, v[240:243] offset:50176
  ds_write_b128 v12, v[244:247] offset:51200
  s_waitcnt lgkmcnt(0)
  s_branch L_now
L_wf:
  s_call_b64 s[98:99], L_wgu
L_now:
  v_mov_b32 v3, 0
L_fw:
  s_sleep 4
  ds_read_b32 v4, v3 offset:10320
  s_waitcnt lgkmcnt(0)
  v_readfirstlane_b32 s58, v4
  s_cmp_lt_u32 s58, 4
  s_cbranch_scc1 L_fw
  s_cmp_ge_u32 s3, 2
  s_cbranch_scc1 L_nopa
  v_lshrrev_b32 v9, 4, v0
  v_cmp_eq_u32 s[68:69], 3, v9
  v_lshlrev_b32 v9, 10, v9
  v_and_b32 v8, 15, v0
  v_lshl_add_u32 v9, v8, 4, v9
  s_and_b32 s59, s3, 1
  s_lshl_b32 s58, s59, 8
  s_add_u32 s58, s58, 4096
  v_add_u32 v10, s58, v9
  v_lshrrev_b32 v1, 5, v0
  v_lshlrev_b32 v1, 7, v1
  v_and_b32 v8, 7, v0
  v_lshl_add_u32 v1, v8, 4, v1
  v_bfe_u32 v8, v0, 3, 1
  v_mul_u32_u24 v8, 6144, v8
  v_add_u32 v1, v1, v8
  s_mul_i32 s58, s50, 24576
  s_mul_i32 s59, s59, 12288
  s_add_u32 s58, s58, s59
  s_lshl_b32 s59, s64, 8
  s_add_u32 s58, s58, s59
  s_add_u32 s58, s58, 176128
  v_mov_b32 v233, s72
  v_mov_b32 v235, s73
  s_call_b64 s[98:99], L_pub
  v_mov_b32 v3, 0
  v_mov_b32 v4, 1
  s_mov_b64 exec, 1
  ds_add_u32 v3, v4 offset:10320
  s_mov_b64 exec, -1
L_nopa:
L_fw2:
  ds_read_b32 v4, v3 offset:10320
  s_waitcnt lgkmcnt(0)
  v_readfirstlane_b32 s58, v4
  s_cmp_lt_u32 s58, 6
  s_cbranch_scc1 L_fw2
L_cnt:
  global_load_dword v4, v3, s[48:49] sc1
  s_waitcnt vmcnt(0)
  v_readfirstlane_b32 s58, v4
  s_cmp_ge_u32 s58, 40
  s_cbranch_scc1 L_cntok
  s_sleep 8
  s_sub_u32 s101, s101, 1
  s_cbranch_scc0 L_cnt
L_cntok:
  s_cmp_lt_u32 s100, 8
  s_cbranch_scc1 L_noearly
  s_sub_u32 s55, s56, 18
  v_mov_b32 v3, 0
L_lw2:
  s_sleep 4
  ds_read_b32 v4, v3 offset:10304
  s_waitcnt lgkmcnt(0)
  v_readfirstlane_b32 s58, v4
  s_cmp_lt_u32 s58, s55
  s_cbranch_scc1 L_lw2
  s_mov_b32 s71, 2
  s_add_u32 s7, s3, 4
  s_branch L_T2
L_earlyback:
  s_mov_b32 s71, 0
  s_mov_b32 s5, 3
L_noearly:
  s_cmp_lg_u32 s5, 1
  s_cbranch_scc1 L_nowd
  s_cmp_lt_u32 s53, 12
  s_cbranch_scc1 L_nowd
  s_call_b64 s[98:99], L_wd
L_nowd:
  s_mov_b32 s71, 1
  s_mov_b32 s22, 0
  s_mov_b32 s46, 0
  s_mov_b64 s[8:9], s[72:73]
  s_mov_b64 s[72:73], 0
  s_cmp_ge_u32 s3, 2
  s_cbranch_scc1 L_dryback
  s_lshl_b32 s7, s3, 2
  s_branch L_tail
L_dryback:
  s_waitcnt vmcnt(0)
  s_mov_b32 s71, 0
  s_mov_b32 s7, s3
  s_mov_b64 s[72:73], s[8:9]
  s_mov_b32 s22, 1010432
  s_mov_b32 s46, 1280
  s_cmp_lg_u32 s3, 3
  s_cbranch_scc1 L_nosched
  v_mov_b32 v3, 0
  s_mov_b32 s55, 0
  s_mul_i32 s54, s51, 4352
  s_add_u32 s54, s54, 962560
L_sw:
  ds_read_b32 v4, v3 offset:10304
  s_add_u32 s59, s55, s56
  s_waitcnt lgkmcnt(0)
  v_readfirstlane_b32 s58, v4
  s_cmp_ge_u32 s58, s59
  s_cbranch_scc1 L_sgo
  s_sleep 2
  s_branch L_sw
L_sgo:
  s_mov_b32 s60, 1
  s_atomic_add s60, s[20:21], s54 glc
  s_waitcnt lgkmcnt(0)
  s_add_u32 s60, s60, 1
  s_cmp_eq_u32 s66, 24
  s_movk_i32 s58, 96
  s_cselect_b32 s58, 152, s58
  s_cmp_ge_u32 s60, s58
  s_cbranch_scc1 L_send
  s_mov_b32 s59, 14
  s_mov_b32 s57, 0
  s_mul_i32 s58, s66, 1
  s_cmp_ge_u32 s60, s58
  s_cselect_b32 s59, 8, s59
  s_cselect_b32 s57, 6, s57
  s_mul_i32 s58, s66, 2
  s_cmp_ge_u32 s60, s58
  s_cselect_b32 s59, 5, s59
  s_cselect_b32 s57, 12, s57
  s_mul_i32 s58, s66, 3
  s_cmp_ge_u32 s60, s58
  s_cselect_b32 s59, 2, s59
  s_cselect_b32 s57, 21, s57
  s_mul_i32 s57, s57, s66
  s_mul_i32 s58, s60, s59
  s_add_u32 s58, s58, s57
  s_bfm_b64 exec, s59, 0
  v_add_u32 v5, s58, v0
  v_add_lshl_u32 v6, s55, v0, 2
  ds_write_b32 v6, v5 offset:11264
  s_mov_b64 exec, -1
  s_add_u32 s55, s55, s59
  s_cmp_lt_u32 s55, 960
  s_cbranch_scc1 L_sw
L_send:
  v_mov_b32 v4, 1
  ds_write_b32 v3, v4 offset:10308
  s_waitcnt lgkmcnt(0)
L_nosched:
  s_cmp_lg_u32 s5, 1
  s_cbranch_scc1 L_noprep
  v_lshrrev_b32 v12, 4, v0
  v_and_b32 v13, 15, v0
  v_lshrrev_b32 v10, 5, v0
  v_lshlrev_b32 v10, 8, v10
  v_lshl_add_u32 v10, v13, 4, v10
  v_and_b32 v9, 1, v12
  v_lshl_add_u32 v10, v9, 3, v10
  v_lshlrev_b32 v9, 3, v13
  v_add_u32 v9, 512, v9
  v_mul_u32_u24 v4, 5120, v12
  v_lshl_add_u32 v24, v13, 4, v4
  v_add_u32 v25, v9, v4
  v_bfe_u32 v11, v0, 2, 2
  v_mul_u32_u24 v11, 96, v11
  v_mul_u32_u24 v4, 24, v12
  s_mul_i32 s58, s3, 384
  v_add3_u32 v11, v11, v4, s58
  v_lshrrev_b32 v4, 1, v10
  v_lshrrev_b32 v5, 1, v9
  s_mul_i32 s59, s3, 320
  buffer_load_dword v17, v4, s[24:27], s59 offen
  buffer_load_dword v19, v5, s[24:27], s59 offen
  v_mov_b32 v28, 0
  v_mov_b32 v29, 0
  v_mov_b32 v30, 0
  v_mov_b32 v31, 0
  v_mov_b32 v32, 0
  v_mov_b32 v33, 0
  v_mov_b32 v34, 0
  v_mov_b32 v35, 0
  v_mov_b32 v36, 0
  v_mov_b32 v37, 0
  v_mov_b32 v38, 0
  v_mov_b32 v39, 0
  v_mov_b32 v40, 0
  v_mov_b32 v41, 0
  v_mov_b32 v42, 0
  v_mov_b32 v43, 0
  v_mov_b32 v44, 0
  v_mov_b32 v45, 0
  v_mov_b32 v46, 0
  v_mov_b32 v47, 0
  v_mov_b32 v48, 0
  v_mov_b32 v49, 0
  v_mov_b32 v50, 0
  v_mov_b32 v51, 0
  v_mov_b32 v4, 0x3f803f80
  v_dot2c_f32_bf16 v28, v56, v4
  v_dot2c_f32_bf16 v29, v57, v4
  v_dot2c_f32_bf16 v30, v58, v4
  v_dot2c_f32_bf16 v31, v59, v4
  v_dot2c_f32_bf16 v32, v60, v4
  v_dot2c_f32_bf16 v33, v61, v4
  v_dot2c_f32_bf16 v34, v62, v4
  v_dot2c_f32_bf16 v35, v63, v4
  v_dot2c_f32_bf16 v36, v64, v4
  v_dot2c_f32_bf16 v37, v65, v4
  v_dot2c_f32_bf16 v38, v66, v4
  v_dot2c_f32_bf16 v39, v67, v4
  v_dot2c_f32_bf16 v40, v68, v4
  v_dot2c_f32_bf16 v41, v69, v4
  v_dot2c_f32_bf16 v42, v70, v4
  v_dot2c_f32_bf16 v43, v71, v4
  v_dot2c_f32_bf16 v44, v72, v4
  v_dot2c_f32_bf16 v45, v73, v4
  v_dot2c_f32_bf16 v46, v74, v4
  v_dot2c_f32_bf16 v47, v75, v4
  v_dot2c_f32_bf16 v48, v76, v4
  v_dot2c_f32_bf16 v49, v77, v4
  v_dot2c_f32_bf16 v50, v78, v4
  v_dot2c_f32_bf16 v51, v79, v4
  v_dot2c_f32_bf16 v28, v80, v4
  v_dot2c_f32_bf16 v29, v81, v4
  v_dot2c_f32_bf16 v30, v82, v4
  v_dot2c_f32_bf16 v31, v83, v4
  v_dot2c_f32_bf16 v32, v84, v4
  v_dot2c_f32_bf16 v33, v85, v4
  v_dot2c_f32_bf16 v34, v86, v4
  v_dot2c_f32_bf16 v35, v87, v4
  v_dot2c_f32_bf16 v36, v88, v4
  v_dot2c_f32_bf16 v37, v89, v4
  v_dot2c_f32_bf16 v38, v90, v4
  v_dot2c_f32_bf16 v39, v91, v4
  v_dot2c_f32_bf16 v40, v92, v4
  v_dot2c_f32_bf16 v41, v93, v4
  v_dot2c_f32_bf16 v42, v94, v4
  v_dot2c_f32_bf16 v43, v95, v4
  v_dot2c_f32_bf16 v44, v96, v4
  v_dot2c_f32_bf16 v45, v97, v4
  v_dot2c_f32_bf16 v46, v98, v4
  v_dot2c_f32_bf16 v47, v99, v4
  v_dot2c_f32_bf16 v48, v100, v4
  v_dot2c_f32_bf16 v49, v101, v4
  v_dot2c_f32_bf16 v50, v102, v4
  v_dot2c_f32_bf16 v51, v103, v4
  v_dot2c_f32_bf16 v28, v104, v4
  v_dot2c_f32_bf16 v29, v105, v4
  v_dot2c_f32_bf16 v30, v106, v4
  v_dot2c_f32_bf16 v31, v107, v4
  v_dot2c_f32_bf16 v32, v108, v4
  v_dot2c_f32_bf16 v33, v109, v4
  v_dot2c_f32_bf16 v34, v110, v4
  v_dot2c_f32_bf16 v35, v111, v4
  v_dot2c_f32_bf16 v36, v112, v4
  v_dot2c_f32_bf16 v37, v113, v4
  v_dot2c_f32_bf16 v38, v114, v4
  v_dot2c_f32_bf16 v39, v115, v4
  v_dot2c_f32_bf16 v40, v116, v4
  v_dot2c_f32_bf16 v41, v117, v4
  v_dot2c_f32_bf16 v42, v118, v4
  v_dot2c_f32_bf16 v43, v119, v4
  v_dot2c_f32_bf16 v44, v120, v4
  v_dot2c_f32_bf16 v45, v121, v4
  v_dot2c_f32_bf16 v46, v122, v4
  v_dot2c_f32_bf16 v47, v123, v4
  v_dot2c_f32_bf16 v48, v124, v4
  v_dot2c_f32_bf16 v49, v125, v4
  v_dot2c_f32_bf16 v50, v126, v4
  v_dot2c_f32_bf16 v51, v127, v4
  v_dot2c_f32_bf16 v28, v128, v4
  v_dot2c_f32_bf16 v29, v129, v4
  v_dot2c_f32_bf16 v30, v130, v4
  v_dot2c_f32_bf16 v31, v131, v4
  v_dot2c_f32_bf16 v32, v132, v4
  v_dot2c_f32_bf16 v33, v133, v4
  v_dot2c_f32_bf16 v34, v134, v4
  v_dot2c_f32_bf16 v35, v135, v4
  v_dot2c_f32_bf16 v36, v136, v4
  v_dot2c_f32_bf16 v37, v137, v4
  v_dot2c_f32_bf16 v38, v138, v4
  v_dot2c_f32_bf16 v39, v139, v4
  v_dot2c_f32_bf16 v40, v140, v4
  v_dot2c_f32_bf16 v41, v141, v4
  v_dot2c_f32_bf16 v42, v142, v4
  v_dot2c_f32_bf16 v43, v143, v4
  v_dot2c_f32_bf16 v44, v144, v4
  v_dot2c_f32_bf16 v45, v145, v4
  v_dot2c_f32_bf16 v46, v146, v4
  v_dot2c_f32_bf16 v47, v147, v4
  v_dot2c_f32_bf16 v48, v148, v4
  v_dot2c_f32_bf16 v49, v149, v4
  v_dot2c_f32_bf16 v50, v150, v4
  v_dot2c_f32_bf16 v51, v151, v4
  v_dot2c_f32_bf16 v28, v152, v4
  v_dot2c_f32_bf16 v29, v153, v4
  v_dot2c_f32_bf16 v30, v154, v4
  v_dot2c_f32_bf16 v31, v155, v4
  v_dot2c_f32_bf16 v32, v156, v4
  v_dot2c_f32_bf16 v33, v157, v4
  v_dot2c_f32_bf16 v34, v158, v4
  v_dot2c_f32_bf16 v35, v159, v4
  v_dot2c_f32_bf16 v36, v160, v4
  v_dot2c_f32_bf16 v37, v161, v4
  v_dot2c_f32_bf16 v38, v162, v4
  v_dot2c_f32_bf16 v39, v163, v4
  v_dot2c_f32_bf16 v40, v164, v4
  v_dot2c_f32_bf16 v41, v165, v4
  v_dot2c_f32_bf16 v42, v166, v4
  v_dot2c_f32_bf16 v43, v167, v4
  v_dot2c_f32_bf16 v44, v168, v4
  v_dot2c_f32_bf16 v45, v169, v4
  v_dot2c_f32_bf16 v46, v170, v4
  v_dot2c_f32_bf16 v47, v171, v4
  v_dot2c_f32_bf16 v48, v172, v4
  v_dot2c_f32_bf16 v49, v173, v4
  v_dot2c_f32_bf16 v50, v174, v4
  v_dot2c_f32_bf16 v51, v175, v4
  v_add_f32_dpp v28, v28, v28 row_ror:8 row_mask:0xf bank_mask:0x3
  v_add_f32_dpp v29, v29, v29 row_ror:8 row_mask:0xf bank_mask:0x3
  v_add_f32_dpp v30, v30, v30 row_ror:8 row_mask:0xf bank_mask:0x3
  v_add_f32_dpp v31, v31, v31 row_ror:8 row_mask:0xf bank_mask:0x3
  v_add_f32_dpp v32, v32, v32 row_ror:8 row_mask:0xf bank_mask:0x3
  v_add_f32_dpp v33, v33, v33 row_ror:8 row_mask:0xf bank_mask:0x3
  v_add_f32_dpp v34, v34, v34 row_ror:8 row_mask:0xf bank_mask:0x3
  v_add_f32_dpp v35, v35, v35 row_ror:8 row_mask:0xf bank_mask:0x3
  v_add_f32_dpp v36, v36, v36 row_ror:8 row_mask:0xf bank_mask:0x3
  v_add_f32_dpp v37, v37, v37 row_ror:8 row_mask:0xf bank_mask:0x3
  v_add_f32_dpp v38, v38, v38 row_ror:8 row_mask:0xf bank_mask:0x3
  v_add_f32_dpp v39, v39, v39 row_ror:8 row_mask:0xf bank_mask:0x3
  v_add_f32_dpp v28, v40, v40 row_ror:8 row_mask:0xf bank_mask:0xc
  v_add_f32_dpp v29, v41, v41 row_ror:8 row_mask:0xf bank_mask:0xc
  v_add_f32_dpp v30, v42, v42 row_ror:8 row_mask:0xf bank_mask:0xc
  v_add_f32_dpp v31, v43, v43 row_ror:8 row_mask:0xf bank_mask:0xc
  v_add_f32_dpp v32, v44, v44 row_ror:8 row_mask:0xf bank_mask:0xc
  v_add_f32_dpp v33, v45, v45 row_ror:8 row_mask:0xf bank_mask:0xc
  v_add_f32_dpp v34, v46, v46 row_ror:8 row_mask:0xf bank_mask:0xc
  v_add_f32_dpp v35, v47, v47 row_ror:8 row_mask:0xf bank_mask:0xc
  v_add_f32_dpp v36, v48, v48 row_ror:8 row_mask:0xf bank_mask:0xc
  v_add_f32_dpp v37, v49, v49 row_ror:8 row_mask:0xf bank_mask:0xc
  v_add_f32_dpp v38, v50, v50 row_ror:8 row_mask:0xf bank_mask:0xc
  v_add_f32_dpp v39, v51, v51 row_ror:8 row_mask:0xf bank_mask:0xc
  v_add_f32_dpp v28, v28, v28 row_half_mirror row_mask:0xf bank_mask:0x5
  v_add_f32_dpp v29, v29, v29 row_half_mirror row_mask:0xf bank_mask:0x5
  v_add_f32_dpp v30, v30, v30 row_half_mirror row_mask:0xf bank_mask:0x5
  v_add_f32_dpp v31, v31, v31 row_half_mirror row_mask:0xf bank_mask:0x5
  v_add_f32_dpp v32, v32, v32 row_half_mirror row_mask:0xf bank_mask:0x5
  v_add_f32_dpp v33, v33, v33 row_half_mirror row_mask:0xf bank_mask:0x5
  v_add_f32_dpp v28, v34, v34 row_half_mirror row_mask:0xf bank_mask:0xa
  v_add_f32_dpp v29, v35, v35 row_half_mirror row_mask:0xf bank_mask:0xa
  v_add_f32_dpp v30, v36, v36 row_half_mirror row_mask:0xf bank_mask:0xa
  v_add_f32_dpp v31, v37, v37 row_half_mirror row_mask:0xf bank_mask:0xa
  v_add_f32_dpp v32, v38, v38 row_half_mirror row_mask:0xf bank_mask:0xa
  v_add_f32_dpp v33, v39, v39 row_half_mirror row_mask:0xf bank_mask:0xa
  v_add_f32_dpp v28, v28, v28 quad_perm:[1,0,3,2] row_mask:0xf bank_mask:0xf
  v_add_f32_dpp v29, v29, v29 quad_perm:[1,0,3,2] row_mask:0xf bank_mask:0xf
  v_add_f32_dpp v30, v30, v30 quad_perm:[1,0,3,2] row_mask:0xf bank_mask:0xf
  v_add_f32_dpp v31, v31, v31 quad_perm:[1,0,3,2] row_mask:0xf bank_mask:0xf
  v_add_f32_dpp v32, v32, v32 quad_perm:[1,0,3,2] row_mask:0xf bank_mask:0xf
  v_add_f32_dpp v33, v33, v33 quad_perm:[1,0,3,2] row_mask:0xf bank_mask:0xf
  v_add_f32_dpp v28, v28, v28 quad_perm:[2,3,0,1] row_mask:0xf bank_mask:0xf
  v_add_f32_dpp v29, v29, v29 quad_perm:[2,3,0,1] row_mask:0xf bank_mask:0xf
  v_add_f32_dpp v30, v30, v30 quad_perm:[2,3,0,1] row_mask:0xf bank_mask:0xf
  v_add_f32_dpp v31, v31, v31 quad_perm:[2,3,0,1] row_mask:0xf bank_mask:0xf
  v_add_f32_dpp v32, v32, v32 quad_perm:[2,3,0,1] row_mask:0xf bank_mask:0xf
  v_add_f32_dpp v33, v33, v33 quad_perm:[2,3,0,1] row_mask:0xf bank_mask:0xf
  ds_write_b64 v11, v[28:29] offset:19456
  ds_write_b64 v11, v[30:31] offset:19464
  ds_write_b64 v11, v[32:33] offset:19472
  s_lshl_b32 s59, s59, 1
  s_add_u32 s59, s59, 20480
  v_mov_b32 v3, 0
L_lw3:
  s_sleep 4
  ds_read_b32 v4, v3 offset:10308
  s_waitcnt lgkmcnt(0)
  v_readfirstlane_b32 s58, v4
  s_cmp_lt_u32 s58, 1
  s_cbranch_scc1 L_lw3
L_poll2:
  buffer_load_dwordx4 v[224:227], v24, s[20:23], s59 offen offset:0 sc1
  buffer_load_dwordx4 v[228:231], v24, s[20:23], s59 offen offset:256 sc1
  buffer_load_dwordx2 v[248:249], v25, s[20:23], s59 offen offset:0 sc1
  buffer_load_dwordx4 v[232:235], v24, s[20:23], s59 offen offset:2560 sc1
  buffer_load_dwordx4 v[236:239], v24, s[20:23], s59 offen offset:2816 sc1
  buffer_load_dwordx2 v[250:251], v25, s[20:23], s59 offen offset:2560 sc1
  s_waitcnt vmcnt(0)
  v_max3_u32 v3, v224, v225, v226
  v_max3_u32 v3, v3, v227, v228
  v_max3_u32 v3, v3, v229, v230
  v_max3_u32 v3, v3, v231, v232
  v_max3_u32 v3, v3, v233, v234
  v_max3_u32 v3, v3, v235, v236
  v_max3_u32 v3, v3, v237, v238
  v_max3_u32 v3, v3, v239, v248
  v_max3_u32 v3, v3, v249, v250
  v_max_u32 v3, v3, v251
  v_cmp_eq_u32 vcc, -1, v3
  s_cbranch_vccz L_poll2_done
  s_mov_b64 exec, vcc
  s_sleep 4
  s_sub_u32 s101, s101, 1
  s_cbranch_scc0 L_poll2
L_poll2_done:
  s_mov_b64 exec, -1
  v_add_f32 v248, v248, v250
  v_add_f32 v249, v249, v251
  v_mov_b32 v250, v248
  v_mov_b32 v251, v249
  v_add_f32 v224, v224, v232
  v_add_f32 v228, v228, v236
  v_add_f32 v225, v225, v233
  v_add_f32 v229, v229, v237
  v_add_f32 v226, v226, v234
  v_add_f32 v230, v230, v238
  v_add_f32 v227, v227, v235
  v_add_f32 v231, v231, v239
  v_permlane16_swap_b32 v248, v250
  v_permlane16_swap_b32 v249, v251
  v_permlane32_swap_b32 v224, v228
  v_permlane32_swap_b32 v225, v229
  v_permlane32_swap_b32 v226, v230
  v_permlane32_swap_b32 v227, v231
  v_add_f32 v252, v248, v250
  v_add_f32 v248, v248, v250
  v_add_f32 v253, v249, v251
  v_add_f32 v249, v249, v251
  v_add_f32 v224, v224, v228
  v_add_f32 v225, v225, v229
  v_add_f32 v226, v226, v230
  v_add_f32 v227, v227, v231
  v_permlane32_swap_b32 v248, v252
  v_permlane32_swap_b32 v249, v253
  v_permlane16_swap_b32 v224, v226
  v_permlane16_swap_b32 v225, v227
  v_add_f32 v248, v248, v252
  v_add_f32 v249, v249, v253
  v_add_f32 v224, v224, v226
  v_add_f32 v225, v225, v227
  v_mov_b32 v20, v224
  v_mov_b32 v22, v248
  v_lshlrev_b32 v16, 16, v17
  v_and_b32 v17, s63, v17
  v_mov_b32 v21, v225
  v_mov_b32 v23, v249
  v_lshlrev_b32 v18, 16, v19
  v_and_b32 v19, s63, v19
L_noprep:
  v_lshrrev_b32 v9, 4, v0
  v_cmp_eq_u32 s[68:69], 3, v9
  v_lshlrev_b32 v9, 10, v9
  v_and_b32 v8, 15, v0
  v_lshl_add_u32 v9, v8, 4, v9
  s_and_b32 s59, s3, 1
  s_lshl_b32 s58, s59, 8
  s_add_u32 s58, s58, 0
  v_add_u32 v10, s58, v9
  v_lshrrev_b32 v1, 5, v0
  v_lshlrev_b32 v1, 7, v1
  v_and_b32 v8, 7, v0
  v_lshl_add_u32 v1, v8, 4, v1
  v_bfe_u32 v8, v0, 3, 1
  v_mul_u32_u24 v8, 6144, v8
  v_add_u32 v1, v1, v8
  s_mul_i32 s58, s51, 24576
  s_mul_i32 s59, s59, 12288
  s_add_u32 s58, s58, s59
  s_lshl_b32 s59, s65, 8
  s_add_u32 s58, s58, s59
  s_add_u32 s58, s58, 692224
  v_mov_b32 v233, s72
  v_mov_b32 v235, s73
  s_waitcnt lgkmcnt(0)
  s_barrier
  s_cmp_ge_u32 s3, 2
  s_cbranch_scc1 L_tail
  s_call_b64 s[98:99], L_pub
L_tail:
  s_cmp_eq_u32 s5, 1
  s_cbranch_scc1 L_ffn
  s_cmp_lg_u32 s5, 0
  s_cbranch_scc1 L_end
L_T2:
  s_mul_i32 s58, s7, 6144
  v_lshl_add_u32 v3, v0, 4, s58
  ds_read_b128 v[176:179], v3 offset:21504
  ds_read_b128 v[180:183], v3 offset:22528
  ds_read_b128 v[184:187], v3 offset:23552
  ds_read_b128 v[188:191], v3 offset:24576
  ds_read_b128 v[192:195], v3 offset:25600
  ds_read_b128 v[196:199], v3 offset:26624
  s_lshr_b32 s6, s7, 2
  s_lshl_b32 s6, s6, 3
  s_add_u32 s6, s6, s100
  s_cmp_lt_u32 s100, 8
  s_cselect_b32 s58, 16, -8
  s_add_u32 s6, s6, s58
  s_cmp_eq_u32 s6, 21
  s_cselect_b32 s60, 20, 24
  s_cmp_lt_u32 s6, 21
  s_cselect_b32 s60, 12, s60
  v_lshrrev_b32 v3, 3, v0
  v_and_b32 v13, 7, v0
  v_lshlrev_b32 v13, 4, v13
  v_mov_b32 v6, 0xf149f2ca
  v_add_u32 v5, 0, v3
  v_cmp_gt_u32 vcc, s60, v5
  s_nop 1
  v_cndmask_b32 v5, 0, v5, vcc
  v_cndmask_b32 v251, v6, 0, vcc
  v_lshl_add_u32 v248, v5, 8, v13
  v_add_u32 v5, 8, v3
  v_cmp_gt_u32 vcc, s60, v5
  s_nop 1
  v_cndmask_b32 v5, 0, v5, vcc
  v_cndmask_b32 v252, v6, 0, vcc
  v_lshl_add_u32 v249, v5, 8, v13
  v_add_u32 v5, 16, v3
  v_cmp_gt_u32 vcc, s60, v5
  s_nop 1
  v_cndmask_b32 v5, 0, v5, vcc
  v_cndmask_b32 v253, v6, 0, vcc
  v_lshl_add_u32 v250, v5, 8, v13
  s_mul_i32 s59, s6, 24576
  s_and_b32 s58, s7, 3
  s_mul_i32 s58, s58, 6144
  s_add_u32 s59, s59, s58
  s_add_u32 s59, s59, 176128
  v_lshrrev_b32 v11, 2, v0
  s_lshl_b32 s58, s7, 8
  v_lshl_add_u32 v11, v11, 4, s58
  v_bfe_u32 v12, v0, 3, 1
  v_lshl_add_u32 v12, v12, 10, v13
  s_lshl_b32 s58, s7, 7
  v_add_u32 v12, s58, v12
  s_mul_i32 s10, s100, 2560
  s_add_u32 s10, s10, s58
  s_lshl_b32 s58, s4, 8
  s_add_u32 s10, s10, s58
  v_mov_b32 v28, 0
  v_mov_b32 v29, 0
  v_mov_b32 v30, 0
  v_mov_b32 v31, 0
  v_mov_b32 v32, 0
  v_mov_b32 v33, 0
  v_mov_b32 v34, 0
  v_mov_b32 v35, 0
  s_waitcnt lgkmcnt(0)
L_poll3:
  buffer_load_dwordx4 v[228:231], v248, s[20:23], s59 offen offset:128 sc1
  buffer_load_dwordx4 v[236:239], v249, s[20:23], s59 offen offset:128 sc1
  buffer_load_dwordx4 v[244:247], v250, s[20:23], s59 offen offset:128 sc1
  buffer_load_dwordx4 v[224:227], v248, s[20:23], s59 offen offset:0 sc1
  buffer_load_dwordx4 v[232:235], v249, s[20:23], s59 offen offset:0 sc1
  buffer_load_dwordx4 v[240:243], v250, s[20:23], s59 offen offset:0 sc1
  s_waitcnt vmcnt(0)
  v_xor_b32 v3, s72, v225
  v_bitop3_b32 v3, v3, v227, s73 bitop3:0xf6
  v_bitop3_b32 v3, v3, v229, s72 bitop3:0xf6
  v_bitop3_b32 v3, v3, v231, s73 bitop3:0xf6
  v_bitop3_b32 v3, v3, v233, s72 bitop3:0xf6
  v_bitop3_b32 v3, v3, v235, s73 bitop3:0xf6
  v_bitop3_b32 v3, v3, v237, s72 bitop3:0xf6
  v_bitop3_b32 v3, v3, v239, s73 bitop3:0xf6
  v_bitop3_b32 v3, v3, v241, s72 bitop3:0xf6
  v_bitop3_b32 v3, v3, v243, s73 bitop3:0xf6
  v_bitop3_b32 v3, v3, v245, s72 bitop3:0xf6
  v_bitop3_b32 v3, v3, v247, s73 bitop3:0xf6
  v_cmp_ne_u32 vcc, 0, v3
  s_cbranch_vccz L_poll3_done
  s_mov_b64 exec, vcc
  s_sleep 1
  s_sub_u32 s101, s101, 1
  s_cbranch_scc0 L_poll3
L_poll3_done:
  s_mov_b64 exec, -1
  v_add_f32 v238, v238, v252
  v_add_f32 v246, v246, v253
  v_max3_f32 v3, v230, v238, v246
  v_and_b32 v225, s63, v224
  v_and_b32 v233, s63, v232
  v_max_f32_dpp v4, v3, v3 row_ror:8 row_mask:0xf bank_mask:0xf
  v_max_f32_dpp v3, v3, v3 row_ror:8 row_mask:0xf bank_mask:0xf
  v_and_b32 v241, s63, v240
  v_and_b32 v227, s63, v226
  v_permlane16_swap_b32 v3, v4
  v_max_f32 v5, v3, v4
  v_max_f32 v4, v3, v4
  v_and_b32 v235, s63, v234
  v_and_b32 v243, s63, v242
  v_permlane32_swap_b32 v5, v4
  v_max_f32 v3, v5, v4
  v_sub_f32 v231, v230, v3
  v_sub_f32 v239, v238, v3
  v_sub_f32 v247, v246, v3
  v_exp_f32 v231, v231
  v_exp_f32 v239, v239
  v_exp_f32 v247, v247
  v_and_b32 v229, s63, v228
  v_and_b32 v237, s63, v236
  v_and_b32 v245, s63, v244
  v_add_f32 v6, v231, v239
  v_add_f32 v6, v6, v247
  v_lshlrev_b32 v224, 16, v224
  v_lshlrev_b32 v226, 16, v226
  v_add_f32_dpp v7, v6, v6 row_ror:8 row_mask:0xf bank_mask:0xf
  v_add_f32_dpp v6, v6, v6 row_ror:8 row_mask:0xf bank_mask:0xf
  v_lshlrev_b32 v228, 16, v228
  v_lshlrev_b32 v232, 16, v232
  v_permlane16_swap_b32 v6, v7
  v_add_f32 v8, v6, v7
  v_add_f32 v7, v6, v7
  v_lshlrev_b32 v234, 16, v234
  v_lshlrev_b32 v236, 16, v236
  v_permlane32_swap_b32 v8, v7
  v_add_f32 v6, v8, v7
  v_rcp_f32 v6, v6
  v_lshlrev_b32 v240, 16, v240
  v_lshlrev_b32 v242, 16, v242
  v_lshlrev_b32 v244, 16, v244
  v_mul_f32 v224, v224, v231
  v_mul_f32 v228, v228, v231
  v_mul_f32 v225, v225, v231
  v_mul_f32 v229, v229, v231
  v_mul_f32 v226, v226, v231
  v_mul_f32 v227, v227, v231
  v_fmac_f32 v224, v232, v239
  v_fmac_f32 v228, v236, v239
  v_fmac_f32 v225, v233, v239
  v_fmac_f32 v229, v237, v239
  v_fmac_f32 v226, v234, v239
  v_fmac_f32 v227, v235, v239
  v_fmac_f32 v224, v240, v247
  v_fmac_f32 v228, v244, v247
  v_fmac_f32 v225, v241, v247
  v_fmac_f32 v229, v245, v247
  v_fmac_f32 v226, v242, v247
  v_fmac_f32 v227, v243, v247
  v_permlane32_swap_b32 v224, v228
  v_permlane32_swap_b32 v225, v229
  v_permlane32_swap_b32 v226, v230
  v_permlane32_swap_b32 v227, v231
  v_add_f32 v224, v224, v228
  v_add_f32 v225, v225, v229
  v_add_f32 v226, v226, v230
  v_add_f32 v227, v227, v231
  s_nop 0
  v_permlane16_swap_b32 v224, v226
  v_permlane16_swap_b32 v225, v227
  v_add_f32 v224, v224, v226
  v_add_f32 v225, v225, v227
  s_nop 0
  v_add_f32_dpp v224, v224, v224 row_ror:8 row_mask:0xf bank_mask:0xf
  v_add_f32_dpp v225, v225, v225 row_ror:8 row_mask:0xf bank_mask:0xf
  v_mul_f32 v224, v224, v6
  v_mul_f32 v225, v225, v6
  v_cvt_pk_bf16_f32 v232, v224, v225
  v_mov_b32 v233, v232
  s_nop 1
  v_permlane16_swap_b32 v232, v233
  v_mov_b32 v234, v232
  v_mov_b32 v235, v233
  s_nop 0
  v_permlane32_swap_b32 v232, v234
  v_permlane32_swap_b32 v233, v235
  v_dot2c_f32_bf16 v28, v176, v232
  v_dot2c_f32_bf16 v29, v177, v232
  v_dot2c_f32_bf16 v30, v178, v232
  v_dot2c_f32_bf16 v31, v179, v232
  v_dot2c_f32_bf16 v32, v180, v232
  v_dot2c_f32_bf16 v33, v181, v232
  v_dot2c_f32_bf16 v34, v182, v232
  v_dot2c_f32_bf16 v35, v183, v232
  v_dot2c_f32_bf16 v28, v184, v233
  v_dot2c_f32_bf16 v29, v185, v233
  v_dot2c_f32_bf16 v30, v186, v233
  v_dot2c_f32_bf16 v31, v187, v233
  v_dot2c_f32_bf16 v32, v188, v233
  v_dot2c_f32_bf16 v33, v189, v233
  v_dot2c_f32_bf16 v34, v190, v233
  v_dot2c_f32_bf16 v35, v191, v233
  v_dot2c_f32_bf16 v28, v192, v234
  v_dot2c_f32_bf16 v29, v193, v234
  v_dot2c_f32_bf16 v30, v194, v234
  v_dot2c_f32_bf16 v31, v195, v234
  v_dot2c_f32_bf16 v32, v196, v234
  v_dot2c_f32_bf16 v33, v197, v234
  v_dot2c_f32_bf16 v34, v198, v234
  v_dot2c_f32_bf16 v35, v199, v234
  v_add_f32_dpp v28, v28, v28 row_half_mirror row_mask:0xf bank_mask:0x5
  v_add_f32_dpp v29, v29, v29 row_half_mirror row_mask:0xf bank_mask:0x5
  v_add_f32_dpp v30, v30, v30 row_half_mirror row_mask:0xf bank_mask:0x5
  v_add_f32_dpp v31, v31, v31 row_half_mirror row_mask:0xf bank_mask:0x5
  v_add_f32_dpp v28, v32, v32 row_half_mirror row_mask:0xf bank_mask:0xa
  v_add_f32_dpp v29, v33, v33 row_half_mirror row_mask:0xf bank_mask:0xa
  v_add_f32_dpp v30, v34, v34 row_half_mirror row_mask:0xf bank_mask:0xa
  v_add_f32_dpp v31, v35, v35 row_half_mirror row_mask:0xf bank_mask:0xa
  v_add_f32_dpp v28, v28, v28 quad_perm:[1,0,3,2] row_mask:0xf bank_mask:0xf
  v_add_f32_dpp v29, v29, v29 quad_perm:[1,0,3,2] row_mask:0xf bank_mask:0xf
  v_add_f32_dpp v30, v30, v30 quad_perm:[1,0,3,2] row_mask:0xf bank_mask:0xf
  v_add_f32_dpp v31, v31, v31 quad_perm:[1,0,3,2] row_mask:0xf bank_mask:0xf
  v_add_f32_dpp v28, v28, v28 quad_perm:[2,3,0,1] row_mask:0xf bank_mask:0xf
  v_add_f32_dpp v29, v29, v29 quad_perm:[2,3,0,1] row_mask:0xf bank_mask:0xf
  v_add_f32_dpp v30, v30, v30 quad_perm:[2,3,0,1] row_mask:0xf bank_mask:0xf
  v_add_f32_dpp v31, v31, v31 quad_perm:[2,3,0,1] row_mask:0xf bank_mask:0xf
  ds_write_b128 v11, v[28:31] offset:4096
  s_cmp_lg_u32 s71, 0
  s_waitcnt lgkmcnt(0)
  s_cbranch_scc1 L_T2x
  s_barrier
L_T2f:
  s_cmp_ge_u32 s7, 2
  s_cbranch_scc1 L_end
  ds_read_b128 v[224:227], v12 offset:4096
  ds_read_b128 v[228:231], v12 offset:4352
  ds_read_b128 v[232:235], v12 offset:4608
  ds_read_b128 v[236:239], v12 offset:4864
  s_waitcnt lgkmcnt(2)
  v_add_f32 v224, v224, v228
  v_add_f32 v225, v225, v229
  v_add_f32 v226, v226, v230
  v_add_f32 v227, v227, v231
  s_waitcnt lgkmcnt(0)
  v_add_f32 v232, v232, v236
  v_add_f32 v233, v233, v237
  v_add_f32 v234, v234, v238
  v_add_f32 v235, v235, v239
  v_add_f32 v224, v224, v232
  v_add_f32 v225, v225, v233
  v_add_f32 v226, v226, v234
  v_add_f32 v227, v227, v235
  v_add_f32_dpp v224, v224, v224 row_ror:8 row_mask:0xf bank_mask:0xf
  v_add_f32_dpp v225, v225, v225 row_ror:8 row_mask:0xf bank_mask:0xf
  v_add_f32_dpp v226, v226, v226 row_ror:8 row_mask:0xf bank_mask:0xf
  v_add_f32_dpp v227, v227, v227 row_ror:8 row_mask:0xf bank_mask:0xf
  v_min_u32 v224, -2, v224
  v_min_u32 v225, -2, v225
  v_min_u32 v226, -2, v226
  v_min_u32 v227, -2, v227
  s_mov_b64 exec, 0xff
  buffer_store_dwordx4 v[224:227], v13, s[20:23], s10 offen offset:0 sc1
  s_mov_b64 exec, -1
  s_branch L_end
L_ffn:
  s_cmp_lt_u32 s7, 4
  s_cbranch_scc1 L_T3
  v_and_b32 v13, 7, v0
  v_lshlrev_b32 v13, 4, v13
  v_min_u32 v4, 47, v0
  v_lshlrev_b32 v4, 7, v4
  s_mov_b32 s59, 40960
  buffer_load_dword v254, v4, s[20:23], s59 offen sc1
  s_and_b32 s6, s7, 3
  s_cmp_lg_u32 s71, 0
  s_cbranch_scc1 L_T4u
  s_mul_i32 s58, s6, 24576
  v_lshl_add_u32 v3, v0, 4, s58
  ds_read_b128 v[80:83], v3 offset:21504
  ds_read_b128 v[84:87], v3 offset:22528
  ds_read_b128 v[88:91], v3 offset:23552
  ds_read_b128 v[92:95], v3 offset:24576
  ds_read_b128 v[96:99], v3 offset:25600
  ds_read_b128 v[100:103], v3 offset:26624
  ds_read_b128 v[104:107], v3 offset:27648
  ds_read_b128 v[108:111], v3 offset:28672
  ds_read_b128 v[112:115], v3 offset:29696
  ds_read_b128 v[116:119], v3 offset:30720
  ds_read_b128 v[120:123], v3 offset:31744
  ds_read_b128 v[124:127], v3 offset:32768
  ds_read_b128 v[128:131], v3 offset:33792
  ds_read_b128 v[132:135], v3 offset:34816
  ds_read_b128 v[136:139], v3 offset:35840
  ds_read_b128 v[140:143], v3 offset:36864
  ds_read_b128 v[144:147], v3 offset:37888
  ds_read_b128 v[148:151], v3 offset:38912
  ds_read_b128 v[152:155], v3 offset:39936
  ds_read_b128 v[156:159], v3 offset:40960
  ds_read_b128 v[160:163], v3 offset:41984
  ds_read_b128 v[164:167], v3 offset:43008
  ds_read_b128 v[168:171], v3 offset:44032
  ds_read_b128 v[172:175], v3 offset:45056
L_T4u:
  v_min_u32 v15, 47, v0
  v_lshlrev_b32 v15, 2, v15
  s_mov_b32 s11, 0x40000000
  s_cmp_eq_u32 s7, 4
  s_cbranch_scc1 L_T3f
  s_cmp_lg_u32 s71, 0
  s_waitcnt lgkmcnt(0)
  s_cbranch_scc1 L_nb1
  s_barrier
L_nb1:
  s_cmp_lg_u32 s71, 0
  s_cbranch_scc1 L_nb2
  s_barrier
L_nb2:
L_T4:
  s_cmp_lt_u32 s53, 12
  s_cbranch_scc1 L_no4
  v_mov_b32 v28, 0
  v_mov_b32 v29, 0
  v_mov_b32 v30, 0
  v_mov_b32 v31, 0
  v_mov_b32 v32, 0
  v_mov_b32 v33, 0
  v_mov_b32 v34, 0
  v_mov_b32 v35, 0
  v_and_b32 v10, 15, v0
  v_lshlrev_b32 v10, 4, v10
  s_mul_i32 s59, s6, 1536
  s_add_u32 s59, s59, 40960
  v_lshrrev_b32 v11, 2, v0
  s_lshl_b32 s58, s6, 7
  v_lshl_add_u32 v11, v11, 3, s58
  s_sub_u32 s10, s53, 12
  s_lshl_b32 s58, s10, 7
  v_add_u32 v12, s58, v13
  ds_read_b128 v[16:19], v12 offset:15360
  s_lshl_b32 s10, s10, 6
  v_lshrrev_b32 v12, 1, v13
  v_mov_b32 v8, s72
  v_mov_b32 v9, s73
  v_mov_b32 v14, 172032
  s_lshl_b32 s55, s53, 3
  s_add_u32 s55, s55, s7
  s_cmp_eq_u32 s55, 101
  s_cselect_b32 s55, 0, 0x40000000
  s_mov_b32 s60, s59
  s_or_b32 s101, s101, 63
L_poll4:
  buffer_load_dwordx4 v[224:227], v10, s[20:23], s60 offen offset:0 sc1
  buffer_load_dwordx4 v[228:231], v10, s[20:23], s60 offen offset:256 sc1
  buffer_load_dwordx4 v[232:235], v10, s[20:23], s60 offen offset:512 sc1
  buffer_load_dwordx4 v[236:239], v10, s[20:23], s60 offen offset:768 sc1
  buffer_load_dwordx4 v[240:243], v10, s[20:23], s60 offen offset:1024 sc1
  buffer_load_dwordx4 v[244:247], v10, s[20:23], s60 offen offset:1280 sc1
  s_waitcnt vmcnt(0)
  v_xor_b32 v3, s72, v225
  v_bitop3_b32 v3, v3, v227, s73 bitop3:0xf6
  v_bitop3_b32 v3, v3, v229, s72 bitop3:0xf6
  v_bitop3_b32 v3, v3, v231, s73 bitop3:0xf6
  v_bitop3_b32 v3, v3, v233, s72 bitop3:0xf6
  v_bitop3_b32 v3, v3, v235, s73 bitop3:0xf6
  v_bitop3_b32 v3, v3, v237, s72 bitop3:0xf6
  v_bitop3_b32 v3, v3, v239, s73 bitop3:0xf6
  v_bitop3_b32 v3, v3, v241, s72 bitop3:0xf6
  v_bitop3_b32 v3, v3, v243, s73 bitop3:0xf6
  v_bitop3_b32 v3, v3, v245, s72 bitop3:0xf6
  v_bitop3_b32 v3, v3, v247, s73 bitop3:0xf6
  v_cmp_ne_u32 vcc, 0, v3
  s_cbranch_vccz L_poll4_done
  s_mov_b64 exec, vcc
  s_sleep 1
  s_and_b32 s60, s101, 63
  s_cselect_b32 s60, 0, 6144
  s_cbranch_scc1 L_poll4_h
  s_mov_b32 exec_lo, 0x55555555
  s_mov_b32 exec_hi, 0x5555
  buffer_store_dwordx2 v[20:21], v15, s[20:23], s11 offen sc1
  s_mov_b64 exec, -1
  s_mov_b64 exec, vcc
L_poll4_h:
  s_add_u32 s60, s60, s59
  s_sub_u32 s101, s101, 1
  s_cbranch_scc0 L_poll4
L_poll4_done:
  s_mov_b64 exec, -1
  s_mov_b32 exec_lo, 0x55555555
  s_mov_b32 exec_hi, 0x5555
  buffer_store_dwordx2 v[20:21], v15, s[20:23], s11 offen sc1
  s_mov_b64 exec, -1
  s_mov_b64 exec, 1
  buffer_store_dwordx2 v[8:9], v14, s[20:23], s55 offen sc1
  s_mov_b64 exec, -1
  v_dot2c_f32_bf16 v28, v80, v224
  v_dot2c_f32_bf16 v29, v81, v224
  v_dot2c_f32_bf16 v30, v82, v224
  v_dot2c_f32_bf16 v31, v83, v224
  v_dot2c_f32_bf16 v32, v84, v224
  v_dot2c_f32_bf16 v33, v85, v224
  v_dot2c_f32_bf16 v34, v86, v224
  v_dot2c_f32_bf16 v35, v87, v224
  v_dot2c_f32_bf16 v28, v88, v226
  v_dot2c_f32_bf16 v29, v89, v226
  v_dot2c_f32_bf16 v30, v90, v226
  v_dot2c_f32_bf16 v31, v91, v226
  v_dot2c_f32_bf16 v32, v92, v226
  v_dot2c_f32_bf16 v33, v93, v226
  v_dot2c_f32_bf16 v34, v94, v226
  v_dot2c_f32_bf16 v35, v95, v226
  v_dot2c_f32_bf16 v28, v96, v228
  v_dot2c_f32_bf16 v29, v97, v228
  v_dot2c_f32_bf16 v30, v98, v228
  v_dot2c_f32_bf16 v31, v99, v228
  v_dot2c_f32_bf16 v32, v100, v228
  v_dot2c_f32_bf16 v33, v101, v228
  v_dot2c_f32_bf16 v34, v102, v228
  v_dot2c_f32_bf16 v35, v103, v228
  v_dot2c_f32_bf16 v28, v104, v230
  v_dot2c_f32_bf16 v29, v105, v230
  v_dot2c_f32_bf16 v30, v106, v230
  v_dot2c_f32_bf16 v31, v107, v230
  v_dot2c_f32_bf16 v32, v108, v230
  v_dot2c_f32_bf16 v33, v109, v230
  v_dot2c_f32_bf16 v34, v110, v230
  v_dot2c_f32_bf16 v35, v111, v230
  v_dot2c_f32_bf16 v28, v112, v232
  v_dot2c_f32_bf16 v29, v113, v232
  v_dot2c_f32_bf16 v30, v114, v232
  v_dot2c_f32_bf16 v31, v115, v232
  v_dot2c_f32_bf16 v32, v116, v232
  v_dot2c_f32_bf16 v33, v117, v232
  v_dot2c_f32_bf16 v34, v118, v232
  v_dot2c_f32_bf16 v35, v119, v232
  v_dot2c_f32_bf16 v28, v120, v234
  v_dot2c_f32_bf16 v29, v121, v234
  v_dot2c_f32_bf16 v30, v122, v234
  v_dot2c_f32_bf16 v31, v123, v234
  v_dot2c_f32_bf16 v32, v124, v234
  v_dot2c_f32_bf16 v33, v125, v234
  v_dot2c_f32_bf16 v34, v126, v234
  v_dot2c_f32_bf16 v35, v127, v234
  v_dot2c_f32_bf16 v28, v128, v236
  v_dot2c_f32_bf16 v29, v129, v236
  v_dot2c_f32_bf16 v30, v130, v236
  v_dot2c_f32_bf16 v31, v131, v236
  v_dot2c_f32_bf16 v32, v132, v236
  v_dot2c_f32_bf16 v33, v133, v236
  v_dot2c_f32_bf16 v34, v134, v236
  v_dot2c_f32_bf16 v35, v135, v236
  v_dot2c_f32_bf16 v28, v136, v238
  v_dot2c_f32_bf16 v29, v137, v238
  v_dot2c_f32_bf16 v30, v138, v238
  v_dot2c_f32_bf16 v31, v139, v238
  v_dot2c_f32_bf16 v32, v140, v238
  v_dot2c_f32_bf16 v33, v141, v238
  v_dot2c_f32_bf16 v34, v142, v238
  v_dot2c_f32_bf16 v35, v143, v238
  v_dot2c_f32_bf16 v28, v144, v240
  v_dot2c_f32_bf16 v29, v145, v240
  v_dot2c_f32_bf16 v30, v146, v240
  v_dot2c_f32_bf16 v31, v147, v240
  v_dot2c_f32_bf16 v32, v148, v240
  v_dot2c_f32_bf16 v33, v149, v240
  v_dot2c_f32_bf16 v34, v150, v240
  v_dot2c_f32_bf16 v35, v151, v240
  v_dot2c_f32_bf16 v28, v152, v242
  v_dot2c_f32_bf16 v29, v153, v242
  v_dot2c_f32_bf16 v30, v154, v242
  v_dot2c_f32_bf16 v31, v155, v242
  v_dot2c_f32_bf16 v32, v156, v242
  v_dot2c_f32_bf16 v33, v157, v242
  v_dot2c_f32_bf16 v34, v158, v242
  v_dot2c_f32_bf16 v35, v159, v242
  v_dot2c_f32_bf16 v28, v160, v244
  v_dot2c_f32_bf16 v29, v161, v244
  v_dot2c_f32_bf16 v30, v162, v244
  v_dot2c_f32_bf16 v31, v163, v244
  v_dot2c_f32_bf16 v32, v164, v244
  v_dot2c_f32_bf16 v33, v165, v244
  v_dot2c_f32_bf16 v34, v166, v244
  v_dot2c_f32_bf16 v35, v167, v244
  v_dot2c_f32_bf16 v28, v168, v246
  v_dot2c_f32_bf16 v29, v169, v246
  v_dot2c_f32_bf16 v30, v170, v246
  v_dot2c_f32_bf16 v31, v171, v246
  v_dot2c_f32_bf16 v32, v172, v246
  v_dot2c_f32_bf16 v33, v173, v246
  v_dot2c_f32_bf16 v34, v174, v246
  v_dot2c_f32_bf16 v35, v175, v246
  v_add_f32_dpp v28, v28, v28 row_ror:8 row_mask:0xf bank_mask:0x3
  v_add_f32_dpp v29, v29, v29 row_ror:8 row_mask:0xf bank_mask:0x3
  v_add_f32_dpp v30, v30, v30 row_ror:8 row_mask:0xf bank_mask:0x3
  v_add_f32_dpp v31, v31, v31 row_ror:8 row_mask:0xf bank_mask:0x3
  v_add_f32_dpp v28, v32, v32 row_ror:8 row_mask:0xf bank_mask:0xc
  v_add_f32_dpp v29, v33, v33 row_ror:8 row_mask:0xf bank_mask:0xc
  v_add_f32_dpp v30, v34, v34 row_ror:8 row_mask:0xf bank_mask:0xc
  v_add_f32_dpp v31, v35, v35 row_ror:8 row_mask:0xf bank_mask:0xc
  v_add_f32_dpp v28, v28, v28 row_half_mirror row_mask:0xf bank_mask:0x5
  v_add_f32_dpp v29, v29, v29 row_half_mirror row_mask:0xf bank_mask:0x5
  s_nop 0
  v_add_f32_dpp v28, v30, v30 row_half_mirror row_mask:0xf bank_mask:0xa
  v_add_f32_dpp v29, v31, v31 row_half_mirror row_mask:0xf bank_mask:0xa
  s_nop 0
  v_add_f32_dpp v28, v28, v28 quad_perm:[1,0,3,2] row_mask:0xf bank_mask:0xf
  v_add_f32_dpp v29, v29, v29 quad_perm:[1,0,3,2] row_mask:0xf bank_mask:0xf
  s_nop 0
  v_add_f32_dpp v28, v28, v28 quad_perm:[2,3,0,1] row_mask:0xf bank_mask:0xf
  v_add_f32_dpp v29, v29, v29 quad_perm:[2,3,0,1] row_mask:0xf bank_mask:0xf
  ds_write_b64 v11, v[28:29] offset:20992
  s_cmp_lg_u32 s71, 0
  s_waitcnt lgkmcnt(0)
  s_cbranch_scc1 L_nb3
  s_barrier
L_nb3:
  s_cmp_lg_u32 s7, 4
  s_cbranch_scc1 L_end
  ds_read_b128 v[224:227], v13 offset:20992
  ds_read_b128 v[228:231], v13 offset:21120
  ds_read_b128 v[232:235], v13 offset:21248
  ds_read_b128 v[236:239], v13 offset:21376
  s_waitcnt lgkmcnt(2)
  v_add_f32 v224, v224, v228
  v_add_f32 v225, v225, v229
  v_add_f32 v226, v226, v230
  v_add_f32 v227, v227, v231
  s_waitcnt lgkmcnt(0)
  v_add_f32 v232, v232, v236
  v_add_f32 v233, v233, v237
  v_add_f32 v234, v234, v238
  v_add_f32 v235, v235, v239
  v_add_f32 v224, v224, v232
  v_add_f32 v225, v225, v233
  v_add_f32 v226, v226, v234
  v_add_f32 v227, v227, v235
  v_cvt_pk_bf16_f32 v228, v224, v225
  v_lshlrev_b32 v224, 16, v228
  v_and_b32 v225, s63, v228
  v_cvt_pk_bf16_f32 v229, v226, v227
  v_lshlrev_b32 v226, 16, v229
  v_and_b32 v227, s63, v229
  v_add_f32 v224, v224, v16
  v_add_f32 v225, v225, v17
  v_add_f32 v226, v226, v18
  v_add_f32 v227, v227, v19
  v_cvt_pk_bf16_f32 v224, v224, v225
  v_cvt_pk_bf16_f32 v225, v226, v227
  s_mov_b64 exec, 0xff
  buffer_store_dwordx2 v[224:225], v12, s[44:47], s10 offen
  s_mov_b64 exec, -1
  s_branch L_end
L_no4:
  s_waitcnt vmcnt(0)
  s_mov_b32 exec_lo, 0x55555555
  s_mov_b32 exec_hi, 0x5555
  buffer_store_dwordx2 v[20:21], v15, s[20:23], s11 offen sc1
  s_mov_b64 exec, -1
  s_branch L_end
L_T2x:
  s_cmp_eq_u32 s71, 1
  s_cbranch_scc1 L_T2f
  s_cmp_lt_u32 s7, 4
  s_cbranch_scc1 L_T2y
  s_mov_b32 s7, s3
  s_branch L_T2
L_T2y:
  v_mov_b32 v3, 0
  v_mov_b32 v4, 1
  s_mov_b64 exec, 1
  ds_add_u32 v3, v4 offset:10320
  s_mov_b64 exec, -1
  s_cmp_ge_u32 s7, 2
  s_cbranch_scc1 L_end
  v_mov_b32 v3, 0
L_lw4:
  ds_read_b32 v4, v3 offset:10320
  s_waitcnt lgkmcnt(0)
  v_readfirstlane_b32 s58, v4
  s_cmp_lt_u32 s58, 10
  s_cbranch_scc1 L_lw4
  s_branch L_T2f
L_T3:
  v_lshrrev_b32 v12, 4, v0
  v_and_b32 v13, 15, v0
  v_lshrrev_b32 v10, 5, v0
  v_lshlrev_b32 v10, 8, v10
  v_lshl_add_u32 v10, v13, 4, v10
  v_and_b32 v9, 1, v12
  v_lshl_add_u32 v10, v9, 3, v10
  v_lshlrev_b32 v9, 3, v13
  v_add_u32 v9, 512, v9
  v_mul_u32_u24 v4, 5120, v12
  v_lshl_add_u32 v24, v13, 4, v4
  v_add_u32 v25, v9, v4
  v_bfe_u32 v11, v0, 2, 2
  v_mul_u32_u24 v11, 96, v11
  v_mul_u32_u24 v4, 24, v12
  s_mul_i32 s58, s3, 384
  v_add3_u32 v11, v11, v4, s58
  v_mov_b32 v28, 0
  v_mov_b32 v29, 0
  v_mov_b32 v30, 0
  v_mov_b32 v31, 0
  v_mov_b32 v32, 0
  v_mov_b32 v33, 0
  v_mov_b32 v34, 0
  v_mov_b32 v35, 0
  v_mov_b32 v36, 0
  v_mov_b32 v37, 0
  v_mov_b32 v38, 0
  v_mov_b32 v39, 0
  v_mov_b32 v40, 0
  v_mov_b32 v41, 0
  v_mov_b32 v42, 0
  v_mov_b32 v43, 0
  v_mov_b32 v44, 0
  v_mov_b32 v45, 0
  v_mov_b32 v46, 0
  v_mov_b32 v47, 0
  v_mov_b32 v48, 0
  v_mov_b32 v49, 0
  v_mov_b32 v50, 0
  v_mov_b32 v51, 0
  s_mul_i32 s59, s3, 640
  v_add_u32 v10, s59, v10
  v_add_u32 v9, s59, v9
  s_lshl_b32 s58, s3, 3
  v_mov_b32 v13, s58
  s_mov_b32 s55, 0x3e800000
L_poll5:
  buffer_load_dwordx4 v[224:227], v24, s[20:23], s59 offen offset:0 sc1
  buffer_load_dwordx4 v[228:231], v24, s[20:23], s59 offen offset:256 sc1
  buffer_load_dwordx2 v[248:249], v25, s[20:23], s59 offen offset:0 sc1
  buffer_load_dwordx4 v[232:235], v24, s[20:23], s59 offen offset:2560 sc1
  buffer_load_dwordx4 v[236:239], v24, s[20:23], s59 offen offset:2816 sc1
  buffer_load_dwordx2 v[250:251], v25, s[20:23], s59 offen offset:2560 sc1
  s_waitcnt vmcnt(0)
  v_max3_u32 v3, v224, v225, v226
  v_max3_u32 v3, v3, v227, v228
  v_max3_u32 v3, v3, v229, v230
  v_max3_u32 v3, v3, v231, v232
  v_max3_u32 v3, v3, v233, v234
  v_max3_u32 v3, v3, v235, v236
  v_max3_u32 v3, v3, v237, v238
  v_max3_u32 v3, v3, v239, v248
  v_max3_u32 v3, v3, v249, v250
  v_max_u32 v3, v3, v251
  v_cmp_eq_u32 vcc, -1, v3
  s_cbranch_vccz L_poll5_done
  s_mov_b64 exec, vcc
  s_sleep 1
  s_sub_u32 s101, s101, 1
  s_cbranch_scc0 L_poll5
L_poll5_done:
  s_mov_b64 exec, -1
  v_add_f32 v248, v248, v250
  v_add_f32 v249, v249, v251
  v_mov_b32 v250, v248
  v_mov_b32 v251, v249
  v_add_f32 v224, v224, v232
  v_add_f32 v228, v228, v236
  v_add_f32 v225, v225, v233
  v_add_f32 v229, v229, v237
  v_add_f32 v226, v226, v234
  v_add_f32 v230, v230, v238
  v_add_f32 v227, v227, v235
  v_add_f32 v231, v231, v239
  v_permlane16_swap_b32 v248, v250
  v_permlane16_swap_b32 v249, v251
  v_permlane32_swap_b32 v224, v228
  v_permlane32_swap_b32 v225, v229
  v_permlane32_swap_b32 v226, v230
  v_permlane32_swap_b32 v227, v231
  v_add_f32 v252, v248, v250
  v_add_f32 v248, v248, v250
  v_add_f32 v253, v249, v251
  v_add_f32 v249, v249, v251
  v_add_f32 v224, v224, v228
  v_add_f32 v225, v225, v229
  v_add_f32 v226, v226, v230
  v_add_f32 v227, v227, v231
  v_permlane32_swap_b32 v248, v252
  v_permlane32_swap_b32 v249, v253
  v_permlane16_swap_b32 v224, v226
  v_permlane16_swap_b32 v225, v227
  v_add_f32 v248, v248, v252
  v_add_f32 v249, v249, v253
  v_add_f32 v224, v224, v226
  v_add_f32 v225, v225, v227
  v_add_f32 v226, v248, v22
  v_add_f32 v227, v249, v23
  v_add_f32 v224, v224, v20
  v_add_f32 v225, v225, v21
  v_cvt_pk_bf16_f32 v229, v226, v227
  v_lshlrev_b32 v226, 16, v229
  v_and_b32 v227, s63, v229
  v_cvt_pk_bf16_f32 v228, v224, v225
  v_lshlrev_b32 v224, 16, v228
  v_and_b32 v225, s63, v228
  v_add_f32 v18, v18, v226
  v_add_f32 v19, v19, v227
  v_add_f32 v16, v16, v224
  v_add_f32 v17, v17, v225
  v_cvt_pk_bf16_f32 v236, v18, v19
  v_cvt_pk_bf16_f32 v232, v16, v17
  v_mov_b32 v233, v232
  v_dot2c_f32_bf16 v28, v152, v236
  v_lshlrev_b32 v16, 16, v232
  v_dot2c_f32_bf16 v29, v153, v236
  v_and_b32 v17, s63, v232
  v_dot2c_f32_bf16 v30, v154, v236
  v_permlane16_swap_b32 v232, v233
  v_dot2c_f32_bf16 v31, v155, v236
  v_lshlrev_b32 v18, 16, v236
  v_dot2c_f32_bf16 v32, v156, v236
  v_mov_b32 v234, v232
  v_dot2c_f32_bf16 v33, v157, v236
  v_mov_b32 v235, v233
  v_dot2c_f32_bf16 v34, v158, v236
  v_and_b32 v19, s63, v236
  v_dot2c_f32_bf16 v35, v159, v236
  v_permlane32_swap_b32 v232, v234
  v_dot2c_f32_bf16 v36, v160, v236
  v_permlane32_swap_b32 v233, v235
  v_dot2c_f32_bf16 v37, v161, v236
  v_readfirstlane_b32 s58, v17
  v_dot2c_f32_bf16 v38, v162, v236
  ds_write_b64 v10, v[16:17] offset:15360
  v_dot2c_f32_bf16 v39, v163, v236
  ds_write_b64 v9, v[18:19] offset:15360
  v_dot2c_f32_bf16 v40, v164, v236
  v_subrev_f32 v226, s58, v18
  v_subrev_f32 v227, s58, v19
  v_subrev_f32 v224, s58, v16
  v_subrev_f32 v225, s58, v17
  v_add_f32 v4, v226, v227
  v_mul_f32 v5, v226, v226
  v_fmac_f32 v5, v227, v227
  v_fma_f32 v4, v4, s55, v224
  v_mul_f32 v5, s55, v5
  v_add_f32 v4, v4, v225
  v_fmac_f32 v5, v224, v224
  v_fmac_f32 v5, v225, v225
  v_dot2c_f32_bf16 v41, v165, v236
  v_add_f32_dpp v4, v4, v4 quad_perm:[1,0,3,2] row_mask:0xf bank_mask:0xf
  v_dot2c_f32_bf16 v42, v166, v236
  v_add_f32_dpp v5, v5, v5 quad_perm:[1,0,3,2] row_mask:0xf bank_mask:0xf
  v_dot2c_f32_bf16 v43, v167, v236
  v_add_f32_dpp v4, v4, v4 quad_perm:[2,3,0,1] row_mask:0xf bank_mask:0xf
  v_dot2c_f32_bf16 v44, v168, v236
  v_add_f32_dpp v5, v5, v5 quad_perm:[2,3,0,1] row_mask:0xf bank_mask:0xf
  v_dot2c_f32_bf16 v45, v169, v236
  v_add_f32_dpp v4, v4, v4 row_half_mirror row_mask:0xf bank_mask:0xf
  v_dot2c_f32_bf16 v46, v170, v236
  v_add_f32_dpp v5, v5, v5 row_half_mirror row_mask:0xf bank_mask:0xf
  v_dot2c_f32_bf16 v47, v171, v236
  v_add_f32_dpp v4, v4, v4 row_ror:8 row_mask:0xf bank_mask:0xf
  v_dot2c_f32_bf16 v48, v172, v236
  v_add_f32_dpp v5, v5, v5 row_ror:8 row_mask:0xf bank_mask:0xf
  v_dot2c_f32_bf16 v49, v173, v236
  v_mov_b32 v226, v4
  v_dot2c_f32_bf16 v50, v174, v236
  v_mov_b32 v227, v5
  v_dot2c_f32_bf16 v51, v175, v236
  v_dot2c_f32_bf16 v28, v56, v232
  v_permlane16_swap_b32 v4, v226
  v_dot2c_f32_bf16 v29, v57, v232
  v_permlane16_swap_b32 v5, v227
  v_dot2c_f32_bf16 v30, v58, v232
  v_add_f32 v4, v4, v226
  v_dot2c_f32_bf16 v31, v59, v232
  v_add_f32 v5, v5, v227
  v_dot2c_f32_bf16 v32, v60, v232
  v_mov_b32 v226, v4
  v_dot2c_f32_bf16 v33, v61, v232
  v_mov_b32 v227, v5
  v_dot2c_f32_bf16 v34, v62, v232
  v_dot2c_f32_bf16 v35, v63, v232
  v_permlane32_swap_b32 v4, v226
  v_dot2c_f32_bf16 v36, v64, v232
  v_permlane32_swap_b32 v5, v227
  v_dot2c_f32_bf16 v37, v65, v232
  v_add_f32 v4, v4, v226
  v_dot2c_f32_bf16 v38, v66, v232
  v_add_f32 v5, v5, v227
  v_dot2c_f32_bf16 v39, v67, v232
  v_mul_f32 v224, 0x3bcccccd, v4
  v_dot2c_f32_bf16 v40, v68, v232
  v_fma_f32 v5, -v224, v4, v5
  v_dot2c_f32_bf16 v41, v69, v232
  v_add_f32 v4, s58, v224
  v_dot2c_f32_bf16 v42, v70, v232
  ds_write_b64 v13, v[4:5] offset:10240
  v_dot2c_f32_bf16 v43, v71, v232
  v_dot2c_f32_bf16 v44, v72, v232
  v_dot2c_f32_bf16 v45, v73, v232
  v_dot2c_f32_bf16 v46, v74, v232
  v_dot2c_f32_bf16 v47, v75, v232
  v_dot2c_f32_bf16 v48, v76, v232
  v_dot2c_f32_bf16 v49, v77, v232
  v_dot2c_f32_bf16 v50, v78, v232
  v_dot2c_f32_bf16 v51, v79, v232
  v_dot2c_f32_bf16 v28, v104, v234
  v_dot2c_f32_bf16 v29, v105, v234
  v_dot2c_f32_bf16 v30, v106, v234
  v_dot2c_f32_bf16 v31, v107, v234
  v_dot2c_f32_bf16 v32, v108, v234
  v_dot2c_f32_bf16 v33, v109, v234
  s_cmp_lg_u32 s71, 0
  s_waitcnt lgkmcnt(0)
  s_cbranch_scc1 L_nb4
  s_barrier
L_nb4:
  v_dot2c_f32_bf16 v34, v110, v234
  v_dot2c_f32_bf16 v35, v111, v234
  v_dot2c_f32_bf16 v36, v112, v234
  v_dot2c_f32_bf16 v37, v113, v234
  v_dot2c_f32_bf16 v38, v114, v234
  v_dot2c_f32_bf16 v39, v115, v234
  v_dot2c_f32_bf16 v40, v116, v234
  v_dot2c_f32_bf16 v41, v117, v234
  v_dot2c_f32_bf16 v42, v118, v234
  v_dot2c_f32_bf16 v43, v119, v234
  v_dot2c_f32_bf16 v44, v120, v234
  v_dot2c_f32_bf16 v45, v121, v234
  v_dot2c_f32_bf16 v46, v122, v234
  v_dot2c_f32_bf16 v47, v123, v234
  v_dot2c_f32_bf16 v48, v124, v234
  v_dot2c_f32_bf16 v49, v125, v234
  v_dot2c_f32_bf16 v50, v126, v234
  v_dot2c_f32_bf16 v51, v127, v234
  v_dot2c_f32_bf16 v28, v80, v233
  v_dot2c_f32_bf16 v29, v81, v233
  v_dot2c_f32_bf16 v30, v82, v233
  v_dot2c_f32_bf16 v31, v83, v233
  v_dot2c_f32_bf16 v32, v84, v233
  v_dot2c_f32_bf16 v33, v85, v233
  v_dot2c_f32_bf16 v34, v86, v233
  v_dot2c_f32_bf16 v35, v87, v233
  v_dot2c_f32_bf16 v36, v88, v233
  v_dot2c_f32_bf16 v37, v89, v233
  v_dot2c_f32_bf16 v38, v90, v233
  v_dot2c_f32_bf16 v39, v91, v233
  v_dot2c_f32_bf16 v40, v92, v233
  v_dot2c_f32_bf16 v41, v93, v233
  v_dot2c_f32_bf16 v42, v94, v233
  v_dot2c_f32_bf16 v43, v95, v233
  v_dot2c_f32_bf16 v44, v96, v233
  v_dot2c_f32_bf16 v45, v97, v233
  v_dot2c_f32_bf16 v46, v98, v233
  v_dot2c_f32_bf16 v47, v99, v233
  v_dot2c_f32_bf16 v48, v100, v233
  v_dot2c_f32_bf16 v49, v101, v233
  v_dot2c_f32_bf16 v50, v102, v233
  v_dot2c_f32_bf16 v51, v103, v233
  v_dot2c_f32_bf16 v28, v128, v235
  v_dot2c_f32_bf16 v29, v129, v235
  v_dot2c_f32_bf16 v30, v130, v235
  v_dot2c_f32_bf16 v31, v131, v235
  v_dot2c_f32_bf16 v32, v132, v235
  v_dot2c_f32_bf16 v33, v133, v235
  v_dot2c_f32_bf16 v34, v134, v235
  v_dot2c_f32_bf16 v35, v135, v235
  v_dot2c_f32_bf16 v36, v136, v235
  v_dot2c_f32_bf16 v37, v137, v235
  v_dot2c_f32_bf16 v38, v138, v235
  v_dot2c_f32_bf16 v39, v139, v235
  v_dot2c_f32_bf16 v40, v140, v235
  v_dot2c_f32_bf16 v41, v141, v235
  v_dot2c_f32_bf16 v42, v142, v235
  v_dot2c_f32_bf16 v43, v143, v235
  v_dot2c_f32_bf16 v44, v144, v235
  v_dot2c_f32_bf16 v45, v145, v235
  v_dot2c_f32_bf16 v46, v146, v235
  v_dot2c_f32_bf16 v47, v147, v235
  v_dot2c_f32_bf16 v48, v148, v235
  v_dot2c_f32_bf16 v49, v149, v235
  v_dot2c_f32_bf16 v50, v150, v235
  v_dot2c_f32_bf16 v51, v151, v235
  v_add_f32_dpp v28, v28, v28 row_ror:8 row_mask:0xf bank_mask:0x3
  v_add_f32_dpp v29, v29, v29 row_ror:8 row_mask:0xf bank_mask:0x3
  v_add_f32_dpp v30, v30, v30 row_ror:8 row_mask:0xf bank_mask:0x3
  v_add_f32_dpp v31, v31, v31 row_ror:8 row_mask:0xf bank_mask:0x3
  v_add_f32_dpp v32, v32, v32 row_ror:8 row_mask:0xf bank_mask:0x3
  v_add_f32_dpp v33, v33, v33 row_ror:8 row_mask:0xf bank_mask:0x3
  v_add_f32_dpp v34, v34, v34 row_ror:8 row_mask:0xf bank_mask:0x3
  v_add_f32_dpp v35, v35, v35 row_ror:8 row_mask:0xf bank_mask:0x3
  v_add_f32_dpp v36, v36, v36 row_ror:8 row_mask:0xf bank_mask:0x3
  v_add_f32_dpp v37, v37, v37 row_ror:8 row_mask:0xf bank_mask:0x3
  v_add_f32_dpp v38, v38, v38 row_ror:8 row_mask:0xf bank_mask:0x3
  v_add_f32_dpp v39, v39, v39 row_ror:8 row_mask:0xf bank_mask:0x3
  v_add_f32_dpp v28, v40, v40 row_ror:8 row_mask:0xf bank_mask:0xc
  v_add_f32_dpp v29, v41, v41 row_ror:8 row_mask:0xf bank_mask:0xc
  v_add_f32_dpp v30, v42, v42 row_ror:8 row_mask:0xf bank_mask:0xc
  v_add_f32_dpp v31, v43, v43 row_ror:8 row_mask:0xf bank_mask:0xc
  v_add_f32_dpp v32, v44, v44 row_ror:8 row_mask:0xf bank_mask:0xc
  v_add_f32_dpp v33, v45, v45 row_ror:8 row_mask:0xf bank_mask:0xc
  v_add_f32_dpp v34, v46, v46 row_ror:8 row_mask:0xf bank_mask:0xc
  v_add_f32_dpp v35, v47, v47 row_ror:8 row_mask:0xf bank_mask:0xc
  v_add_f32_dpp v36, v48, v48 row_ror:8 row_mask:0xf bank_mask:0xc
  v_add_f32_dpp v37, v49, v49 row_ror:8 row_mask:0xf bank_mask:0xc
  v_add_f32_dpp v38, v50, v50 row_ror:8 row_mask:0xf bank_mask:0xc
  v_add_f32_dpp v39, v51, v51 row_ror:8 row_mask:0xf bank_mask:0xc
  v_add_f32_dpp v28, v28, v28 row_half_mirror row_mask:0xf bank_mask:0x5
  v_add_f32_dpp v29, v29, v29 row_half_mirror row_mask:0xf bank_mask:0x5
  v_add_f32_dpp v30, v30, v30 row_half_mirror row_mask:0xf bank_mask:0x5
  v_add_f32_dpp v31, v31, v31 row_half_mirror row_mask:0xf bank_mask:0x5
  v_add_f32_dpp v32, v32, v32 row_half_mirror row_mask:0xf bank_mask:0x5
  v_add_f32_dpp v33, v33, v33 row_half_mirror row_mask:0xf bank_mask:0x5
  v_add_f32_dpp v28, v34, v34 row_half_mirror row_mask:0xf bank_mask:0xa
  v_add_f32_dpp v29, v35, v35 row_half_mirror row_mask:0xf bank_mask:0xa
  v_add_f32_dpp v30, v36, v36 row_half_mirror row_mask:0xf bank_mask:0xa
  v_add_f32_dpp v31, v37, v37 row_half_mirror row_mask:0xf bank_mask:0xa
  v_add_f32_dpp v32, v38, v38 row_half_mirror row_mask:0xf bank_mask:0xa
  v_add_f32_dpp v33, v39, v39 row_half_mirror row_mask:0xf bank_mask:0xa
  v_add_f32_dpp v28, v28, v28 quad_perm:[1,0,3,2] row_mask:0xf bank_mask:0xf
  v_add_f32_dpp v29, v29, v29 quad_perm:[1,0,3,2] row_mask:0xf bank_mask:0xf
  v_add_f32_dpp v30, v30, v30 quad_perm:[1,0,3,2] row_mask:0xf bank_mask:0xf
  v_add_f32_dpp v31, v31, v31 quad_perm:[1,0,3,2] row_mask:0xf bank_mask:0xf
  v_add_f32_dpp v32, v32, v32 quad_perm:[1,0,3,2] row_mask:0xf bank_mask:0xf
  v_add_f32_dpp v33, v33, v33 quad_perm:[1,0,3,2] row_mask:0xf bank_mask:0xf
  v_add_f32_dpp v28, v28, v28 quad_perm:[2,3,0,1] row_mask:0xf bank_mask:0xf
  v_add_f32_dpp v29, v29, v29 quad_perm:[2,3,0,1] row_mask:0xf bank_mask:0xf
  v_add_f32_dpp v30, v30, v30 quad_perm:[2,3,0,1] row_mask:0xf bank_mask:0xf
  v_add_f32_dpp v31, v31, v31 quad_perm:[2,3,0,1] row_mask:0xf bank_mask:0xf
  v_add_f32_dpp v32, v32, v32 quad_perm:[2,3,0,1] row_mask:0xf bank_mask:0xf
  v_add_f32_dpp v33, v33, v33 quad_perm:[2,3,0,1] row_mask:0xf bank_mask:0xf
  ds_write_b64 v11, v[28:29] offset:17920
  ds_write_b64 v11, v[30:31] offset:17928
  ds_write_b64 v11, v[32:33] offset:17936
  s_cmp_lg_u32 s71, 0
  s_waitcnt lgkmcnt(0)
  s_cbranch_scc1 L_nb5
  s_barrier
L_nb5:
  s_branch L_end
L_T3f:
  v_mov_b32 v11, v15
  v_mov_b32 v14, 0
  v_and_b32 v3, 2, v0
  v_cmp_eq_u32 vcc, 0, v3
  v_mov_b32 v3, s73
  v_mov_b32 v4, s72
  v_cndmask_b32 v22, v3, v4, vcc
  s_mul_i32 s10, s53, 192
  s_add_u32 s10, s10, 40960
  s_add_u32 s11, s10, 6144
  s_waitcnt vmcnt(0) lgkmcnt(0)
  ds_read_b32 v224, v11 offset:19456
  ds_read_b32 v225, v11 offset:19840
  ds_read_b32 v226, v11 offset:20224
  ds_read_b32 v227, v11 offset:20608
  ds_read_b32 v232, v11 offset:19648
  ds_read_b32 v233, v11 offset:20032
  ds_read_b32 v234, v11 offset:20416
  ds_read_b32 v235, v11 offset:20800
  s_waitcnt lgkmcnt(4)
  v_add_f32 v224, v224, v225
  v_add_f32 v226, v226, v227
  v_add_f32 v20, v224, v226
  s_waitcnt lgkmcnt(0)
  v_add_f32 v232, v232, v233
  v_add_f32 v234, v234, v235
  v_add_f32 v21, v232, v234
  s_cmp_lg_u32 s71, 0
  s_cbranch_scc1 L_nb6
  s_barrier
L_nb6:
  ds_read_b128 v[224:227], v14 offset:10240
  ds_read_b128 v[228:231], v14 offset:10256
  s_waitcnt lgkmcnt(0)
  v_add_f32 v3, v224, v226
  v_add_f32 v5, v228, v230
  v_add_f32 v4, v225, v227
  v_add_f32 v3, v3, v5
  v_add_f32 v4, v4, v229
  v_mul_f32 v3, 0x3e800000, v3
  v_add_f32 v4, v4, v231
  v_sub_f32 v224, v224, v3
  v_sub_f32 v226, v226, v3
  v_sub_f32 v228, v228, v3
  v_sub_f32 v230, v230, v3
  v_mul_f32 v5, v224, v224
  v_fmac_f32 v5, v226, v226
  v_fmac_f32 v5, v228, v228
  v_fmac_f32 v5, v230, v230
  v_fmac_f32 v4, 0x43200000, v5
  v_mul_f32 v4, 0x3acccccd, v4
  v_max_f32 v4, 0, v4
  v_cvt_pk_bf16_f32 v5, v4, v3
  v_lshlrev_b32 v4, 16, v5
  v_and_b32 v3, s63, v5
  v_add_f32 v4, 0x3727c5ac, v4
  v_mul_f32 v20, v20, v3
  v_mul_f32 v21, v21, v3
  v_cvt_pk_bf16_f32 v4, v4, v4
  v_lshlrev_b32 v4, 16, v4
  v_sqrt_f32 v5, v4
  s_nop 0
  v_cvt_pk_bf16_f32 v5, v5, v5
  v_lshlrev_b32 v5, 16, v5
  v_rcp_f32 v6, v5
  s_cmp_lg_u32 s71, 0
  s_cbranch_scc1 L_nb7
  s_barrier
L_nb7:
  ds_read_b32 v224, v11 offset:17920
  ds_read_b32 v225, v11 offset:18304
  ds_read_b32 v226, v11 offset:18688
  ds_read_b32 v227, v11 offset:19072
  ds_read_b32 v232, v11 offset:18112
  ds_read_b32 v233, v11 offset:18496
  ds_read_b32 v234, v11 offset:18880
  ds_read_b32 v235, v11 offset:19264
  s_waitcnt lgkmcnt(4)
  v_add_f32 v224, v224, v225
  v_add_f32 v226, v226, v227
  v_add_f32 v224, v224, v226
  v_sub_f32 v224, v224, v20
  v_mul_f32 v224, v224, v6
  v_cvt_pk_bf16_f32 v224, v224, v224
  v_lshlrev_b32 v224, 16, v224
  v_mul_f32 v3, s62, v224
  v_exp_f32 v3, -v3
  s_waitcnt lgkmcnt(0)
  v_add_f32 v232, v232, v233
  v_add_f32 v234, v234, v235
  v_add_f32 v232, v232, v234
  v_add_f32 v3, 1.0, v3
  v_rcp_f32 v3, v3
  v_sub_f32 v232, v232, v21
  v_mul_f32 v232, v232, v6
  v_mul_f32 v224, v224, v3
  v_cvt_pk_bf16_f32 v3, v224, v232
  v_lshlrev_b32 v224, 16, v3
  v_and_b32 v232, s63, v3
  v_mul_f32 v224, v224, v232
  v_mov_b32 v21, v22
  s_nop 0
  v_mov_b32_dpp v3, v224 quad_perm:[1,0,3,2] row_mask:0xf bank_mask:0xf
  s_mov_b32 exec_lo, 0x55555555
  s_mov_b32 exec_hi, 0x5555
  v_cvt_pk_bf16_f32 v20, v224, v3
  buffer_store_dwordx2 v[20:21], v11, s[20:23], s10 offen
  s_mov_b64 exec, -1
  s_branch L_T4
L_end:
  s_cmp_eq_u32 s71, 1
  s_cbranch_scc1 L_dryback
  s_cmp_eq_u32 s71, 2
  s_cbranch_scc1 L_earlyback
L_exit:
  s_endpgm
L_rare:
  v_max_f32_dpp v3, v6, v6 row_ror:8 row_mask:0xf bank_mask:0xf
  v_mov_b32 v4, v3
  s_nop 1
  v_permlane16_swap_b32 v3, v4
  v_max_f32 v3, v3, v4
  v_mov_b32 v4, v3
  s_nop 1
  v_permlane32_swap_b32 v3, v4
  v_max_f32 v3, v3, v4
  v_max_f32 v53, v53, v3
  v_mul_f32 v3, s62, v53
  v_sub_f32 v4, v54, v3
  v_exp_f32 v4, v4
  v_mov_b32 v54, v3
  v_mul_f32 v28, v28, v4
  v_mul_f32 v29, v29, v4
  v_mul_f32 v30, v30, v4
  v_mul_f32 v31, v31, v4
  v_mul_f32 v32, v32, v4
  v_mul_f32 v33, v33, v4
  v_mul_f32 v34, v34, v4
  v_mul_f32 v35, v35, v4
  v_mul_f32 v36, v36, v4
  v_mul_f32 v37, v37, v4
  v_mul_f32 v38, v38, v4
  v_mul_f32 v39, v39, v4
  v_mul_f32 v40, v40, v4
  v_mul_f32 v41, v41, v4
  v_mul_f32 v42, v42, v4
  v_mul_f32 v43, v43, v4
  v_mul_f32 v44, v44, v4
  v_mul_f32 v45, v45, v4
  v_mul_f32 v46, v46, v4
  v_mul_f32 v47, v47, v4
  v_mul_f32 v48, v48, v4
  v_mul_f32 v49, v49, v4
  v_mul_f32 v50, v50, v4
  v_mul_f32 v51, v51, v4
  v_mul_f32 v52, v52, v4
  s_branch L_back
L_p1x:
  s_mov_b64 s[8:9], s[66:67]
  s_mov_b64 s[12:13], s[66:67]
  s_sub_u32 s60, s55, s37
  s_branch L_p1b
L_rot:
  s_memrealtime s[90:91]
  s_add_u32 s26, s26, 1
  s_mov_b32 s59, 1
  s_mov_b32 s60, 0
  s_cmp_eq_u32 s26, 1
  s_cselect_b32 s59, 30, s59
  s_cselect_b32 s60, 143165577, s60
  s_cmp_eq_u32 s26, 3
  s_cselect_b32 s59, 18, s59
  s_cselect_b32 s60, 238609295, s60
  s_cmp_eq_u32 s26, 4
  s_cselect_b32 s59, 42, s59
  s_cselect_b32 s60, 102261127, s60
  s_cmp_eq_u32 s26, 6
  s_cselect_b32 s59, 18, s59
  s_cselect_b32 s60, 238609295, s60
  s_cmp_eq_u32 s26, 4
  s_cselect_b32 s24, 0, s24
  s_lshl_b32 s19, s59, 2
  s_add_u32 s19, s19, s24
  s_cmp_eq_u32 s60, 0
  s_cselect_b32 s19, s36, s19
  s_min_u32 s19, s19, s37
  s_sub_u32 s58, s19, s24
  s_mov_b32 s24, s19
  s_mov_b32 s19, s58
  s_add_u32 s25, s25, s19
  s_waitcnt lgkmcnt(0)
  s_and_b32 s90, s90, 0xfffff
  s_mul_i32 s90, s90, 780
  s_lshr_b32 s90, s90, 16
  s_mul_hi_u32 s91, s90, s60
  s_mul_i32 s91, s91, s59
  s_sub_u32 s90, s90, s91
  s_lshl_b32 s90, s90, 2
  s_cmp_lt_u32 s90, s19
  s_cselect_b32 s90, s90, 0
  s_lshl_b32 s58, s26, 2
  v_mov_b32 v8, s58
  v_mov_b32 v9, -1
  v_mov_b32 v10, s90
  s_mov_b64 exec, 1
  ds_cmpst_rtn_b32 v11, v8, v9, v10 offset:15272
  s_mov_b64 exec, -1
  s_waitcnt lgkmcnt(0)
  v_readfirstlane_b32 s16, v11
  s_cmp_eq_u32 s16, -1
  s_cselect_b32 s16, s90, s16
  s_cmp_eq_u32 s26, 6
  s_cselect_b32 s25, -1, s25
  s_cmp_ge_u32 s55, s25
  s_cbranch_scc1 L_rot
  s_setpc_b64 s[98:99]
L_p1s:
  v_and_b32 v3, 7, v0
  v_lshlrev_b32 v3, 4, v3
  ds_read_b128 v[16:19], v3 offset:8704
  ds_read_b128 v[20:23], v3 offset:8832
  ds_read_b128 v[24:27], v3 offset:8960
  v_mov_b32 v248, v53
  v_mov_b32 v53, 0xfe967699
  s_mov_b32 s39, s37
  s_waitcnt lgkmcnt(0)
  s_branch L_p1c
L_p2s:
  s_mov_b64 exec, 1
  ds_add_u32 v14, v15 offset:10320
  s_mov_b64 exec, -1
  v_mov_b32 v28, 0
  v_mov_b32 v29, 0
  v_mov_b32 v30, 0
  v_mov_b32 v31, 0
  v_mov_b32 v32, 0
  v_mov_b32 v33, 0
  v_mov_b32 v34, 0
  v_mov_b32 v35, 0
  v_mov_b32 v36, 0
  v_mov_b32 v37, 0
  v_mov_b32 v38, 0
  v_mov_b32 v39, 0
  v_mov_b32 v40, 0
  v_mov_b32 v41, 0
  v_mov_b32 v42, 0
  v_mov_b32 v43, 0
  v_mov_b32 v44, 0
  v_mov_b32 v45, 0
  v_mov_b32 v46, 0
  v_mov_b32 v47, 0
  v_mov_b32 v48, 0
  v_mov_b32 v49, 0
  v_mov_b32 v50, 0
  v_mov_b32 v51, 0
  v_mov_b32 v52, 0
  v_mul_f32 v54, s62, v53
  v_subrev_u32 v2, 4096, v2
  s_mov_b32 s39, s38
  s_branch L_p2c
L_p2x:
  s_mov_b64 s[8:9], s[64:65]
  s_call_b64 s[98:99], L_dyn
  s_branch L_p2b
L_dyn:
  s_sub_u32 s60, s55, s38
  s_min_u32 s60, s60, 1000
  s_lshl_b32 s60, s60, 2
  v_mov_b32 v8, s60
L_dspin:
  ds_read_b32 v9, v14 offset:10308
  ds_read_b32 v10, v8 offset:11264
  s_waitcnt lgkmcnt(0)
  v_readfirstlane_b32 s58, v10
  v_readfirstlane_b32 s59, v9
  s_add_u32 s54, s58, s56
  s_lshl_b32 s60, s33, 1
  s_sub_u32 s60, s54, s60
  s_cselect_b32 s54, s54, s60
  s_mul_i32 s54, s54, 3072
  s_add_u32 s54, s54, s35
  s_cmp_lg_u32 s58, -1
  s_cbranch_scc1 L_dynr
  s_cmp_lg_u32 s59, 0
  s_cbranch_scc1 L_dynf
  s_sleep 1
  s_branch L_dspin
L_dynf:
  s_mov_b32 s70, 1
  s_mov_b32 s54, 0x40000000
L_dynr:
  s_mov_b32 s68, s54
  s_setpc_b64 s[98:99]
L_pub:
  ds_read_b128 v[228:231], v10 offset:512
  ds_read_b128 v[224:227], v10
  s_waitcnt lgkmcnt(1)
  v_mov_b32 v3, v230
  v_mov_b32 v4, v3
  s_nop 1
  v_permlane16_swap_b32 v3, v4
  v_max_f32 v3, v3, v4
  v_mov_b32 v4, v3
  s_nop 1
  v_permlane32_swap_b32 v3, v4
  v_max_f32 v3, v3, v4
  v_sub_f32 v4, v230, v3
  v_exp_f32 v4, v4
  s_waitcnt lgkmcnt(0)
  v_mul_f32 v6, v231, v4
  v_mul_f32 v7, v231, v4
  v_mul_f32 v224, v224, v4
  v_mul_f32 v228, v228, v4
  v_permlane16_swap_b32 v6, v7
  v_add_f32 v5, v6, v7
  v_add_f32 v7, v6, v7
  v_mul_f32 v225, v225, v4
  v_mul_f32 v229, v229, v4
  v_permlane32_swap_b32 v5, v7
  v_add_f32 v5, v5, v7
  v_mul_f32 v226, v226, v4
  v_mul_f32 v227, v227, v4
  v_rcp_f32 v6, v5
  v_log_f32 v7, v5
  v_permlane32_swap_b32 v224, v228
  v_permlane32_swap_b32 v225, v229
  v_permlane32_swap_b32 v226, v230
  v_permlane32_swap_b32 v227, v231
  v_add_f32 v224, v224, v228
  v_add_f32 v225, v225, v229
  v_add_f32 v226, v226, v230
  v_add_f32 v227, v227, v231
  s_nop 0
  v_permlane16_swap_b32 v224, v226
  v_permlane16_swap_b32 v225, v227
  v_add_f32 v224, v224, v226
  v_add_f32 v225, v225, v227
  v_add_f32 v7, v7, v3
  v_mul_f32 v224, v224, v6
  v_mul_f32 v225, v225, v6
  v_cvt_pk_bf16_f32 v232, v224, v225
  v_cndmask_b32 v232, v232, v7, s[68:69]
  v_mov_b32 v234, v232
  s_nop 1
  v_permlane16_swap_b32 v232, v234
  s_mov_b32 exec_lo, 0xffff
  s_mov_b32 exec_hi, 0xffff
  buffer_store_dwordx4 v[232:235], v1, s[20:23], s58 offen sc1
  s_mov_b64 exec, -1
  s_setpc_b64 s[98:99]
L_wo:
  s_lshr_b32 s6, s7, 2
  s_lshl_b32 s6, s6, 3
  s_add_u32 s6, s6, s100
  s_cmp_lt_u32 s100, 8
  s_cselect_b32 s58, 16, -8
  s_add_u32 s6, s6, s58
  v_lshrrev_b32 v9, 3, v0
  v_and_b32 v10, 7, v0
  v_lshl_add_u32 v12, v10, 3, v9
  v_mul_u32_u24 v9, 2560, v9
  v_lshl_add_u32 v9, v10, 4, v9
  s_mul_i32 s58, s7, 6144
  v_lshl_add_u32 v12, v12, 4, s58
  s_mul_i32 s58, s6, 245760
  s_and_b32 s59, s7, 3
  s_mul_i32 s59, s59, 20480
  s_add_u32 s58, s58, s59
  s_lshl_b32 s59, s4, 7
  s_add_u32 s58, s58, s59
  buffer_load_dwordx4 v[16:19], v9, s[28:31], s58 offen offset:0
  buffer_load_dwordx4 v[20:23], v9, s[28:31], s58 offen offset:1280
  s_add_u32 s58, s58, 81920
  buffer_load_dwordx4 v[24:27], v9, s[28:31], s58 offen offset:0
  buffer_load_dwordx4 v[28:31], v9, s[28:31], s58 offen offset:1280
  s_add_u32 s58, s58, 81920
  buffer_load_dwordx4 v[32:35], v9, s[28:31], s58 offen offset:0
  buffer_load_dwordx4 v[36:39], v9, s[28:31], s58 offen offset:1280
  s_waitcnt vmcnt(0)
  v_perm_b32 v224, v20, v16, s74
  v_perm_b32 v225, v20, v16, s75
  v_perm_b32 v226, v21, v17, s74
  v_perm_b32 v227, v21, v17, s75
  v_perm_b32 v228, v22, v18, s74
  v_perm_b32 v229, v22, v18, s75
  v_perm_b32 v230, v23, v19, s74
  v_perm_b32 v231, v23, v19, s75
  v_perm_b32 v232, v28, v24, s74
  v_perm_b32 v233, v28, v24, s75
  v_perm_b32 v234, v29, v25, s74
  v_perm_b32 v235, v29, v25, s75
  v_perm_b32 v236, v30, v26, s74
  v_perm_b32 v237, v30, v26, s75
  v_perm_b32 v238, v31, v27, s74
  v_perm_b32 v239, v31, v27, s75
  v_perm_b32 v240, v36, v32, s74
  v_perm_b32 v241, v36, v32, s75
  v_perm_b32 v242, v37, v33, s74
  v_perm_b32 v243, v37, v33, s75
  v_perm_b32 v244, v38, v34, s74
  v_perm_b32 v245, v38, v34, s75
  v_perm_b32 v246, v39, v35, s74
  v_perm_b32 v247, v39, v35, s75
  ds_write_b128 v12, v[224:227] offset:21504
  ds_write_b128 v12, v[228:231] offset:22528
  ds_write_b128 v12, v[232:235] offset:23552
  ds_write_b128 v12, v[236:239] offset:24576
  ds_write_b128 v12, v[240:243] offset:25600
  ds_write_b128 v12, v[244:247] offset:26624
  s_waitcnt lgkmcnt(0)
  s_setpc_b64 s[98:99]
L_wgu:
  v_lshrrev_b32 v9, 2, v0
  v_and_b32 v10, 3, v0
  v_lshl_add_u32 v12, v10, 4, v9
  s_mul_i32 s58, s3, 24576
  v_lshl_add_u32 v12, v12, 4, s58
  v_lshl_add_u32 v13, v0, 4, s58
  v_mul_u32_u24 v11, 6144, v9
  v_lshlrev_b32 v9, 1, v11
  v_mul_u32_u24 v10, 12, v10
  v_add_u32 v11, v11, v10
  v_add_u32 v9, v9, v10
  s_mul_i32 s58, s3, 491520
  s_mul_i32 s59, s53, 96
  s_add_u32 s58, s58, s59
  buffer_load_dwordx3 v[16:18], v9, s[32:35], s58 offen offset:0
  buffer_load_dwordx3 v[20:22], v9, s[32:35], s58 offen offset:48
  buffer_load_dwordx3 v[24:26], v9, s[36:39], s58 offen offset:0
  buffer_load_dwordx3 v[28:30], v9, s[36:39], s58 offen offset:48
  s_waitcnt vmcnt(0)
  buffer_load_dwordx3 v[32:34], v9, s[32:35], s58 offen offset:3072
  buffer_load_dwordx3 v[36:38], v9, s[32:35], s58 offen offset:3120
  buffer_load_dwordx3 v[40:42], v9, s[36:39], s58 offen offset:3072
  buffer_load_dwordx3 v[44:46], v9, s[36:39], s58 offen offset:3120
  s_waitcnt vmcnt(0)
  s_add_u32 s58, s58, 6144
  v_perm_b32 v224, v32, v16, s74
  v_perm_b32 v225, v32, v16, s75
  v_perm_b32 v226, v33, v17, s74
  v_perm_b32 v227, v33, v17, s75
  v_perm_b32 v228, v34, v18, s74
  v_perm_b32 v229, v34, v18, s75
  v_perm_b32 v230, v36, v20, s74
  v_perm_b32 v231, v36, v20, s75
  v_perm_b32 v232, v37, v21, s74
  v_perm_b32 v233, v37, v21, s75
  v_perm_b32 v234, v38, v22, s74
  v_perm_b32 v235, v38, v22, s75
  v_perm_b32 v236, v40, v24, s74
  v_perm_b32 v237, v40, v24, s75
  v_perm_b32 v238, v41, v25, s74
  v_perm_b32 v239, v41, v25, s75
  v_perm_b32 v240, v42, v26, s74
  v_perm_b32 v241, v42, v26, s75
  v_perm_b32 v242, v44, v28, s74
  v_perm_b32 v243, v44, v28, s75
  v_perm_b32 v244, v45, v29, s74
  v_perm_b32 v245, v45, v29, s75
  v_perm_b32 v246, v46, v30, s74
  v_perm_b32 v247, v46, v30, s75
  ds_write_b128 v12, v[224:227] offset:21504
  ds_write_b128 v12, v[228:231] offset:22528
  ds_write_b128 v12, v[232:235] offset:23552
  ds_write_b128 v12, v[236:239] offset:24576
  ds_write_b128 v12, v[240:243] offset:25600
  ds_write_b128 v12, v[244:247] offset:26624
  ds_read_b128 v[56:59], v13 offset:21504
  ds_read_b128 v[60:63], v13 offset:22528
  ds_read_b128 v[64:67], v13 offset:23552
  ds_read_b128 v[68:71], v13 offset:24576
  ds_read_b128 v[72:75], v13 offset:25600
  ds_read_b128 v[76:79], v13 offset:26624
  s_waitcnt lgkmcnt(0)
  buffer_load_dwordx3 v[16:18], v9, s[32:35], s58 offen offset:0
  buffer_load_dwordx3 v[20:22], v9, s[32:35], s58 offen offset:48
  buffer_load_dwordx3 v[24:26], v9, s[36:39], s58 offen offset:0
  buffer_load_dwordx3 v[28:30], v9, s[36:39], s58 offen offset:48
  s_waitcnt vmcnt(0)
  buffer_load_dwordx3 v[32:34], v9, s[32:35], s58 offen offset:3072
  buffer_load_dwordx3 v[36:38], v9, s[32:35], s58 offen offset:3120
  buffer_load_dwordx3 v[40:42], v9, s[36:39], s58 offen offset:3072
  buffer_load_dwordx3 v[44:46], v9, s[36:39], s58 offen offset:3120
  s_waitcnt vmcnt(0)
  s_add_u32 s58, s58, 190464
  v_perm_b32 v224, v32, v16, s74
  v_perm_b32 v225, v32, v16, s75
  v_perm_b32 v226, v33, v17, s74
  v_perm_b32 v227, v33, v17, s75
  v_perm_b32 v228, v34, v18, s74
  v_perm_b32 v229, v34, v18, s75
  v_perm_b32 v230, v36, v20, s74
  v_perm_b32 v231, v36, v20, s75
  v_perm_b32 v232, v37, v21, s74
  v_perm_b32 v233, v37, v21, s75
  v_perm_b32 v234, v38, v22, s74
  v_perm_b32 v235, v38, v22, s75
  v_perm_b32 v236, v40, v24, s74
  v_perm_b32 v237, v40, v24, s75
  v_perm_b32 v238, v41, v25, s74
  v_perm_b32 v239, v41, v25, s75
  v_perm_b32 v240, v42, v26, s74
  v_perm_b32 v241, v42, v26, s75
  v_perm_b32 v242, v44, v28, s74
  v_perm_b32 v243, v44, v28, s75
  v_perm_b32 v244, v45, v29, s74
  v_perm_b32 v245, v45, v29, s75
  v_perm_b32 v246, v46, v30, s74
  v_perm_b32 v247, v46, v30, s75
  ds_write_b128 v12, v[224:227] offset:21504
  ds_write_b128 v12, v[228:231] offset:22528
  ds_write_b128 v12, v[232:235] offset:23552
  ds_write_b128 v12, v[236:239] offset:24576
  ds_write_b128 v12, v[240:243] offset:25600
  ds_write_b128 v12, v[244:247] offset:26624
  ds_read_b128 v[80:83], v13 offset:21504
  ds_read_b128 v[84:87], v13 offset:22528
  ds_read_b128 v[88:91], v13 offset:23552
  ds_read_b128 v[92:95], v13 offset:24576
  ds_read_b128 v[96:99], v13 offset:25600
  ds_read_b128 v[100:103], v13 offset:26624
  s_waitcnt lgkmcnt(0)
  buffer_load_dwordx3 v[16:18], v9, s[32:35], s58 offen offset:0
  buffer_load_dwordx3 v[20:22], v9, s[32:35], s58 offen offset:48
  buffer_load_dwordx3 v[24:26], v9, s[36:39], s58 offen offset:0
  buffer_load_dwordx3 v[28:30], v9, s[36:39], s58 offen offset:48
  s_waitcnt vmcnt(0)
  buffer_load_dwordx3 v[32:34], v9, s[32:35], s58 offen offset:3072
  buffer_load_dwordx3 v[36:38], v9, s[32:35], s58 offen offset:3120
  buffer_load_dwordx3 v[40:42], v9, s[36:39], s58 offen offset:3072
  buffer_load_dwordx3 v[44:46], v9, s[36:39], s58 offen offset:3120
  s_waitcnt vmcnt(0)
  s_add_u32 s58, s58, 6144
  v_perm_b32 v224, v32, v16, s74
  v_perm_b32 v225, v32, v16, s75
  v_perm_b32 v226, v33, v17, s74
  v_perm_b32 v227, v33, v17, s75
  v_perm_b32 v228, v34, v18, s74
  v_perm_b32 v229, v34, v18, s75
  v_perm_b32 v230, v36, v20, s74
  v_perm_b32 v231, v36, v20, s75
  v_perm_b32 v232, v37, v21, s74
  v_perm_b32 v233, v37, v21, s75
  v_perm_b32 v234, v38, v22, s74
  v_perm_b32 v235, v38, v22, s75
  v_perm_b32 v236, v40, v24, s74
  v_perm_b32 v237, v40, v24, s75
  v_perm_b32 v238, v41, v25, s74
  v_perm_b32 v239, v41, v25, s75
  v_perm_b32 v240, v42, v26, s74
  v_perm_b32 v241, v42, v26, s75
  v_perm_b32 v242, v44, v28, s74
  v_perm_b32 v243, v44, v28, s75
  v_perm_b32 v244, v45, v29, s74
  v_perm_b32 v245, v45, v29, s75
  v_perm_b32 v246, v46, v30, s74
  v_perm_b32 v247, v46, v30, s75
  ds_write_b128 v12, v[224:227] offset:21504
  ds_write_b128 v12, v[228:231] offset:22528
  ds_write_b128 v12, v[232:235] offset:23552
  ds_write_b128 v12, v[236:239] offset:24576
  ds_write_b128 v12, v[240:243] offset:25600
  ds_write_b128 v12, v[244:247] offset:26624
  ds_read_b128 v[104:107], v13 offset:21504
  ds_read_b128 v[108:111], v13 offset:22528
  ds_read_b128 v[112:115], v13 offset:23552
  ds_read_b128 v[116:119], v13 offset:24576
  ds_read_b128 v[120:123], v13 offset:25600
  ds_read_b128 v[124:127], v13 offset:26624
  s_waitcnt lgkmcnt(0)
  buffer_load_dwordx3 v[16:18], v9, s[32:35], s58 offen offset:0
  buffer_load_dwordx3 v[20:22], v9, s[32:35], s58 offen offset:48
  buffer_load_dwordx3 v[24:26], v9, s[36:39], s58 offen offset:0
  buffer_load_dwordx3 v[28:30], v9, s[36:39], s58 offen offset:48
  s_waitcnt vmcnt(0)
  buffer_load_dwordx3 v[32:34], v9, s[32:35], s58 offen offset:3072
  buffer_load_dwordx3 v[36:38], v9, s[32:35], s58 offen offset:3120
  buffer_load_dwordx3 v[40:42], v9, s[36:39], s58 offen offset:3072
  buffer_load_dwordx3 v[44:46], v9, s[36:39], s58 offen offset:3120
  s_waitcnt vmcnt(0)
  s_add_u32 s58, s58, 190464
  v_perm_b32 v224, v32, v16, s74
  v_perm_b32 v225, v32, v16, s75
  v_perm_b32 v226, v33, v17, s74
  v_perm_b32 v227, v33, v17, s75
  v_perm_b32 v228, v34, v18, s74
  v_perm_b32 v229, v34, v18, s75
  v_perm_b32 v230, v36, v20, s74
  v_perm_b32 v231, v36, v20, s75
  v_perm_b32 v232, v37, v21, s74
  v_perm_b32 v233, v37, v21, s75
  v_perm_b32 v234, v38, v22, s74
  v_perm_b32 v235, v38, v22, s75
  v_perm_b32 v236, v40, v24, s74
  v_perm_b32 v237, v40, v24, s75
  v_perm_b32 v238, v41, v25, s74
  v_perm_b32 v239, v41, v25, s75
  v_perm_b32 v240, v42, v26, s74
  v_perm_b32 v241, v42, v26, s75
  v_perm_b32 v242, v44, v28, s74
  v_perm_b32 v243, v44, v28, s75
  v_perm_b32 v244, v45, v29, s74
  v_perm_b32 v245, v45, v29, s75
  v_perm_b32 v246, v46, v30, s74
  v_perm_b32 v247, v46, v30, s75
  ds_write_b128 v12, v[224:227] offset:21504
  ds_write_b128 v12, v[228:231] offset:22528
  ds_write_b128 v12, v[232:235] offset:23552
  ds_write_b128 v12, v[236:239] offset:24576
  ds_write_b128 v12, v[240:243] offset:25600
  ds_write_b128 v12, v[244:247] offset:26624
  ds_read_b128 v[128:131], v13 offset:21504
  ds_read_b128 v[132:135], v13 offset:22528
  ds_read_b128 v[136:139], v13 offset:23552
  ds_read_b128 v[140:143], v13 offset:24576
  ds_read_b128 v[144:147], v13 offset:25600
  ds_read_b128 v[148:151], v13 offset:26624
  s_waitcnt lgkmcnt(0)
  buffer_load_dwordx3 v[16:18], v11, s[32:35], s58 offen offset:0
  buffer_load_dwordx3 v[20:22], v11, s[32:35], s58 offen offset:48
  buffer_load_dwordx3 v[24:26], v11, s[36:39], s58 offen offset:0
  buffer_load_dwordx3 v[28:30], v11, s[36:39], s58 offen offset:48
  s_waitcnt vmcnt(0)
  buffer_load_dwordx3 v[32:34], v11, s[32:35], s58 offen offset:3072
  buffer_load_dwordx3 v[36:38], v11, s[32:35], s58 offen offset:3120
  buffer_load_dwordx3 v[40:42], v11, s[36:39], s58 offen offset:3072
  buffer_load_dwordx3 v[44:46], v11, s[36:39], s58 offen offset:3120
  s_waitcnt vmcnt(0)
  v_perm_b32 v224, v32, v16, s74
  v_perm_b32 v225, v32, v16, s75
  v_perm_b32 v226, v33, v17, s74
  v_perm_b32 v227, v33, v17, s75
  v_perm_b32 v228, v34, v18, s74
  v_perm_b32 v229, v34, v18, s75
  v_perm_b32 v230, v36, v20, s74
  v_perm_b32 v231, v36, v20, s75
  v_perm_b32 v232, v37, v21, s74
  v_perm_b32 v233, v37, v21, s75
  v_perm_b32 v234, v38, v22, s74
  v_perm_b32 v235, v38, v22, s75
  v_perm_b32 v236, v40, v24, s74
  v_perm_b32 v237, v40, v24, s75
  v_perm_b32 v238, v41, v25, s74
  v_perm_b32 v239, v41, v25, s75
  v_perm_b32 v240, v42, v26, s74
  v_perm_b32 v241, v42, v26, s75
  v_perm_b32 v242, v44, v28, s74
  v_perm_b32 v243, v44, v28, s75
  v_perm_b32 v244, v45, v29, s74
  v_perm_b32 v245, v45, v29, s75
  v_perm_b32 v246, v46, v30, s74
  v_perm_b32 v247, v46, v30, s75
  ds_write_b128 v12, v[224:227] offset:21504
  ds_write_b128 v12, v[228:231] offset:22528
  ds_write_b128 v12, v[232:235] offset:23552
  ds_write_b128 v12, v[236:239] offset:24576
  ds_write_b128 v12, v[240:243] offset:25600
  ds_write_b128 v12, v[244:247] offset:26624
  ds_read_b128 v[152:155], v13 offset:21504
  ds_read_b128 v[156:159], v13 offset:22528
  ds_read_b128 v[160:163], v13 offset:23552
  ds_read_b128 v[164:167], v13 offset:24576
  ds_read_b128 v[168:171], v13 offset:25600
  ds_read_b128 v[172:175], v13 offset:26624
  s_waitcnt lgkmcnt(0)
  s_setpc_b64 s[98:99]
L_wd:
  v_lshrrev_b32 v9, 2, v0
  v_and_b32 v10, 3, v0
  v_lshl_add_u32 v12, v10, 4, v9
  s_mul_i32 s58, s3, 24576
  v_lshl_add_u32 v12, v12, 4, s58
  v_lshl_add_u32 v13, v0, 4, s58
  v_mul_u32_u24 v9, 5120, v9
  v_lshl_add_u32 v9, v10, 4, v9
  s_mul_i32 s58, s3, 491520
  s_sub_u32 s59, s53, 12
  s_lshl_b32 s59, s59, 6
  s_add_u32 s58, s58, s59
  buffer_load_dwordx4 v[16:19], v9, s[40:43], s58 offen offset:0
  buffer_load_dwordx4 v[20:23], v9, s[40:43], s58 offen offset:1280
  buffer_load_dwordx4 v[24:27], v9, s[40:43], s58 offen offset:2560
  buffer_load_dwordx4 v[28:31], v9, s[40:43], s58 offen offset:3840
  s_add_u32 s58, s58, 81920
  s_waitcnt vmcnt(0) lgkmcnt(0)
  v_perm_b32 v224, v20, v16, s74
  v_perm_b32 v225, v20, v16, s75
  v_perm_b32 v226, v21, v17, s74
  v_perm_b32 v227, v21, v17, s75
  v_perm_b32 v228, v22, v18, s74
  v_perm_b32 v229, v22, v18, s75
  v_perm_b32 v230, v23, v19, s74
  v_perm_b32 v231, v23, v19, s75
  v_perm_b32 v232, v28, v24, s74
  v_perm_b32 v233, v28, v24, s75
  v_perm_b32 v234, v29, v25, s74
  v_perm_b32 v235, v29, v25, s75
  v_perm_b32 v236, v30, v26, s74
  v_perm_b32 v237, v30, v26, s75
  v_perm_b32 v238, v31, v27, s74
  v_perm_b32 v239, v31, v27, s75
  ds_write_b128 v12, v[224:227] offset:21504
  ds_write_b128 v12, v[228:231] offset:22528
  ds_write_b128 v12, v[232:235] offset:23552
  ds_write_b128 v12, v[236:239] offset:24576
  buffer_load_dwordx4 v[16:19], v9, s[40:43], s58 offen offset:0
  buffer_load_dwordx4 v[20:23], v9, s[40:43], s58 offen offset:1280
  buffer_load_dwordx4 v[24:27], v9, s[40:43], s58 offen offset:2560
  buffer_load_dwordx4 v[28:31], v9, s[40:43], s58 offen offset:3840
  s_add_u32 s58, s58, 81920
  s_waitcnt vmcnt(0) lgkmcnt(0)
  v_perm_b32 v224, v20, v16, s74
  v_perm_b32 v225, v20, v16, s75
  v_perm_b32 v226, v21, v17, s74
  v_perm_b32 v227, v21, v17, s75
  v_perm_b32 v228, v22, v18, s74
  v_perm_b32 v229, v22, v18, s75
  v_perm_b32 v230, v23, v19, s74
  v_perm_b32 v231, v23, v19, s75
  v_perm_b32 v232, v28, v24, s74
  v_perm_b32 v233, v28, v24, s75
  v_perm_b32 v234, v29, v25, s74
  v_perm_b32 v235, v29, v25, s75
  v_perm_b32 v236, v30, v26, s74
  v_perm_b32 v237, v30, v26, s75
  v_perm_b32 v238, v31, v27, s74
  v_perm_b32 v239, v31, v27, s75
  ds_write_b128 v12, v[224:227] offset:25600
  ds_write_b128 v12, v[228:231] offset:26624
  ds_write_b128 v12, v[232:235] offset:27648
  ds_write_b128 v12, v[236:239] offset:28672
  buffer_load_dwordx4 v[16:19], v9, s[40:43], s58 offen offset:0
  buffer_load_dwordx4 v[20:23], v9, s[40:43], s58 offen offset:1280
  buffer_load_dwordx4 v[24:27], v9, s[40:43], s58 offen offset:2560
  buffer_load_dwordx4 v[28:31], v9, s[40:43], s58 offen offset:3840
  s_add_u32 s58, s58, 81920
  s_waitcnt vmcnt(0) lgkmcnt(0)
  v_perm_b32 v224, v20, v16, s74
  v_perm_b32 v225, v20, v16, s75
  v_perm_b32 v226, v21, v17, s74
  v_perm_b32 v227, v21, v17, s75
  v_perm_b32 v228, v22, v18, s74
  v_perm_b32 v229, v22, v18, s75
  v_perm_b32 v230, v23, v19, s74
  v_perm_b32 v231, v23, v19, s75
  v_perm_b32 v232, v28, v24, s74
  v_perm_b32 v233, v28, v24, s75
  v_perm_b32 v234, v29, v25, s74
  v_perm_b32 v235, v29, v25, s75
  v_perm_b32 v236, v30, v26, s74
  v_perm_b32 v237, v30, v26, s75
  v_perm_b32 v238, v31, v27, s74
  v_perm_b32 v239, v31, v27, s75
  ds_write_b128 v12, v[224:227] offset:29696
  ds_write_b128 v12, v[228:231] offset:30720
  ds_write_b128 v12, v[232:235] offset:31744
  ds_write_b128 v12, v[236:239] offset:32768
  buffer_load_dwordx4 v[16:19], v9, s[40:43], s58 offen offset:0
  buffer_load_dwordx4 v[20:23], v9, s[40:43], s58 offen offset:1280
  buffer_load_dwordx4 v[24:27], v9, s[40:43], s58 offen offset:2560
  buffer_load_dwordx4 v[28:31], v9, s[40:43], s58 offen offset:3840
  s_add_u32 s58, s58, 81920
  s_waitcnt vmcnt(0) lgkmcnt(0)
  v_perm_b32 v224, v20, v16, s74
  v_perm_b32 v225, v20, v16, s75
  v_perm_b32 v226, v21, v17, s74
  v_perm_b32 v227, v21, v17, s75
  v_perm_b32 v228, v22, v18, s74
  v_perm_b32 v229, v22, v18, s75
  v_perm_b32 v230, v23, v19, s74
  v_perm_b32 v231, v23, v19, s75
  v_perm_b32 v232, v28, v24, s74
  v_perm_b32 v233, v28, v24, s75
  v_perm_b32 v234, v29, v25, s74
  v_perm_b32 v235, v29, v25, s75
  v_perm_b32 v236, v30, v26, s74
  v_perm_b32 v237, v30, v26, s75
  v_perm_b32 v238, v31, v27, s74
  v_perm_b32 v239, v31, v27, s75
  ds_write_b128 v12, v[224:227] offset:33792
  ds_write_b128 v12, v[228:231] offset:34816
  ds_write_b128 v12, v[232:235] offset:35840
  ds_write_b128 v12, v[236:239] offset:36864
  buffer_load_dwordx4 v[16:19], v9, s[40:43], s58 offen offset:0
  buffer_load_dwordx4 v[20:23], v9, s[40:43], s58 offen offset:1280
  buffer_load_dwordx4 v[24:27], v9, s[40:43], s58 offen offset:2560
  buffer_load_dwordx4 v[28:31], v9, s[40:43], s58 offen offset:3840
  s_add_u32 s58, s58, 81920
  s_waitcnt vmcnt(0) lgkmcnt(0)
  v_perm_b32 v224, v20, v16, s74
  v_perm_b32 v225, v20, v16, s75
  v_perm_b32 v226, v21, v17, s74
  v_perm_b32 v227, v21, v17, s75
  v_perm_b32 v228, v22, v18, s74
  v_perm_b32 v229, v22, v18, s75
  v_perm_b32 v230, v23, v19, s74
  v_perm_b32 v231, v23, v19, s75
  v_perm_b32 v232, v28, v24, s74
  v_perm_b32 v233, v28, v24, s75
  v_perm_b32 v234, v29, v25, s74
  v_perm_b32 v235, v29, v25, s75
  v_perm_b32 v236, v30, v26, s74
  v_perm_b32 v237, v30, v26, s75
  v_perm_b32 v238, v31, v27, s74
  v_perm_b32 v239, v31, v27, s75
  ds_write_b128 v12, v[224:227] offset:37888
  ds_write_b128 v12, v[228:231] offset:38912
  ds_write_b128 v12, v[232:235] offset:39936
  ds_write_b128 v12, v[236:239] offset:40960
  buffer_load_dwordx4 v[16:19], v9, s[40:43], s58 offen offset:0
  buffer_load_dwordx4 v[20:23], v9, s[40:43], s58 offen offset:1280
  buffer_load_dwordx4 v[24:27], v9, s[40:43], s58 offen offset:2560
  buffer_load_dwordx4 v[28:31], v9, s[40:43], s58 offen offset:3840
  s_waitcnt vmcnt(0) lgkmcnt(0)
  v_perm_b32 v224, v20, v16, s74
  v_perm_b32 v225, v20, v16, s75
  v_perm_b32 v226, v21, v17, s74
  v_perm_b32 v227, v21, v17, s75
  v_perm_b32 v228, v22, v18, s74
  v_perm_b32 v229, v22, v18, s75
  v_perm_b32 v230, v23, v19, s74
  v_perm_b32 v231, v23, v19, s75
  v_perm_b32 v232, v28, v24, s74
  v_perm_b32 v233, v28, v24, s75
  v_perm_b32 v234, v29, v25, s74
  v_perm_b32 v235, v29, v25, s75
  v_perm_b32 v236, v30, v26, s74
  v_perm_b32 v237, v30, v26, s75
  v_perm_b32 v238, v31, v27, s74
  v_perm_b32 v239, v31, v27, s75
  ds_write_b128 v12, v[224:227] offset:41984
  ds_write_b128 v12, v[228:231] offset:43008
  ds_write_b128 v12, v[232:235] offset:44032
  ds_write_b128 v12, v[236:239] offset:45056
  s_waitcnt lgkmcnt(0)
  s_setpc_b64 s[98:99]
.section .rodata,"a"
.p2align 6
.amdhsa_kernel sequential_preLN__mha_block_cached__swiglu_ffn__decode_kernel
  .amdhsa_next_free_vgpr 256
  .amdhsa_next_free_sgpr 102
  .amdhsa_accum_offset 256
  .amdhsa_group_segment_fixed_size 0
  .amdhsa_kernarg_size 96
  .amdhsa_user_sgpr_count 2
  .amdhsa_user_sgpr_kernarg_segment_ptr 1
  .amdhsa_system_sgpr_workgroup_id_x 1
  .amdhsa_float_denorm_mode_32 3
.end_amdhsa_kernel
```
